```python
import torch

def _softmax(x, axis=-1):
    return torch.softmax(x, dim=axis)
def _gelu(x):
    return torch.nn.functional.gelu(x, approximate="tanh")
def _silu(x):
    return torch.nn.functional.silu(x)
def _sigmoid(x):
    return torch.sigmoid(x)
def _layernorm(x, axis=-1, eps=1e-5):
    m = x.mean(dim=axis, keepdim=True)
    v = x.var(dim=axis, keepdim=True, unbiased=False)
    return (x - m) / torch.sqrt(v + eps)
def _scatter_add(tgt, idx, src, axis=0):
    return tgt.clone().index_add_(axis, idx, src)
def _segment_sum(src, seg, n):
    out = torch.zeros((n,) + src.shape[1:], dtype=src.dtype)
    return out.index_add_(0, seg, src)
def _pad(x, pw):
    flat = tuple(v for pair in reversed(pw) for v in pair)
    return torch.nn.functional.pad(x, flat)

kernel_name = 'gated_mix__linear_kernel_hedgehog__sliding_block__prompt'

def setup_inputs():

    _w = (lambda a: (lambda t: t.to(torch.bfloat16) if t.is_floating_point() else t)(torch.as_tensor(a)))
    def _A_setup():
        B, S, D, H = 1, 2048, 640, 32
        Dh = D // H
        return {
            "x": _w((lambda *s: torch.randn(*s, dtype=torch.bfloat16) * 0.05)(B, S, D)),
            "wqkv": _w((lambda *s: torch.randn(*s, dtype=torch.bfloat16) * 1.6)(D, 3 * D)),
            "w_phi": _w((lambda *s: torch.randn(*s, dtype=torch.bfloat16) * 1.6)(H, Dh, Dh) * (Dh ** -0.5)),
            "wo": _w((lambda *s: torch.randn(*s, dtype=torch.bfloat16) * 0.1)(D, D)),
        }
    _A_in = _A_setup()

    def _B_setup():
        B, S, D = 1, 2048, 640
        return {
            "x": _w((lambda *s: torch.randn(*s, dtype=torch.bfloat16) * 0.05)(B, S, D)),
            "wqkv": _w((lambda *s: torch.randn(*s, dtype=torch.bfloat16) * 0.8)(D, 3 * D)),
            "wo": _w((lambda *s: torch.randn(*s, dtype=torch.bfloat16) * 0.05)(D, D)),
        }
    _B_in = _B_setup()

    return {
        "A_x": _A_in["x"],
        "A_wqkv": _A_in["wqkv"],
        "A_w_phi": _A_in["w_phi"],
        "A_wo": _A_in["wo"],
        "B_x": _B_in["x"],
        "B_wqkv": _B_in["wqkv"],
        "B_wo": _B_in["wo"],
        "gate_w": _w((lambda *s: torch.randn(*s, dtype=torch.bfloat16) * 0.05)(640) * 16.0),
    }

def reference(A_x, A_wqkv, A_w_phi, A_wo, B_x, B_wqkv, B_wo, gate_w):
    def _A_ref(x, wqkv, w_phi, wo):
        B, S, D = x.shape
        H = 32; Dh = D // H
        qkv = (lambda x, *d: x.permute(*d))((x @ wqkv).reshape(B, S, 3, H, Dh), 2, 0, 3, 1, 4)
        q, k, v = qkv[0], qkv[1], qkv[2]
        pq = torch.einsum("bhsd,hdf->bhsf", q, w_phi)
        pk = torch.einsum("bhsd,hdf->bhsf", k, w_phi)
        phi_q = torch.concatenate([_softmax(pq, axis=-1), _softmax(-pq, axis=-1)], axis=-1)
        phi_k = torch.concatenate([_softmax(pk, axis=-1), _softmax(-pk, axis=-1)], axis=-1)
        kv = torch.einsum("bhsf,bhsd->bhfd", phi_k, v)
        z  = torch.einsum("bhsf->bhf", phi_k)
        num = torch.einsum("bhqf,bhfd->bhqd", phi_q, kv)
        den = torch.einsum("bhqf,bhf->bhq", phi_q, z)[..., None] + 1e-6
        o = num / den
        return (lambda x, *d: x.permute(*d))(o, 0, 2, 1, 3).reshape(B, S, D) @ wo

    def _B_ref(x, wqkv, wo):
        B, S, D = x.shape
        H = 32; Dh = D // H; W = 256
        qkv = (lambda x, *d: x.permute(*d))((x @ wqkv).reshape(B, S, 3, H, Dh), 2, 0, 3, 1, 4)
        q, k, v = qkv[0], qkv[1], qkv[2]
        scores = torch.einsum("bhqd,bhkd->bhqk", q, k) * (Dh ** -0.5)
        idx = torch.arange(S)
        mask = (idx[:, None] - idx[None, :] >= 0) & (idx[:, None] - idx[None, :] < W)
        scores = torch.where(mask[None, None], scores, -1e9)
        p = _softmax(scores, axis=-1)
        o = torch.einsum("bhqk,bhkd->bhqd", p, v)
        return (lambda x, *d: x.permute(*d))(o, 0, 2, 1, 3).reshape(B, S, D) @ wo

    x = A_x
    g = _sigmoid((x * gate_w).sum(-1, keepdims=True))
    a = _A_ref(x, A_wqkv, A_w_phi, A_wo)
    b = _B_ref(x, B_wqkv, B_wo)
    return g * a + (1 - g) * b
```

```asm
; @launch grid=(256,1,1) block=(768,1,1) lds=163840
.amdgcn_target "amdgcn-amd-amdhsa--gfx950"
.text
.globl gated_mix__linear_kernel_hedgehog__sliding_block__prompt_kernel
.p2align 12
.p2align 8
.type gated_mix__linear_kernel_hedgehog__sliding_block__prompt_kernel,@function
gated_mix__linear_kernel_hedgehog__sliding_block__prompt_kernel:
L_start:
  s_load_dwordx16 s[36:51], s[0:1], 0
  s_cmp_ge_u32 s2, 256
  s_cbranch_scc1 L_exit
  v_lshrrev_b32 v2, 6, v0
  v_and_b32 v1, 63, v0
  v_readfirstlane_b32 s20, v2
  s_lshr_b32 s24, s2, 6
  s_xor_b32 s25, s20, 5
  s_or_b32 s24, s24, s25
  s_cbranch_scc1 L_nocode
  s_getpc_b64 s[64:65]
L_pc:
  s_lshr_b32 s24, s2, 3
  s_lshl_b32 s24, s24, 12
  v_lshl_add_u32 v4, v1, 7, s24
  v_min_u32 v4, L_exit-L_pc, v4
  v_mov_b32 v5, s65
  v_add_co_u32 v4, vcc, s64, v4
  s_nop 1
  v_addc_co_u32 v5, vcc, 0, v5, vcc
  s_mov_b32 exec_lo, 0xffffffff
  s_mov_b32 exec_hi, 0
  global_load_dword v167, v[4:5], off
  s_mov_b64 exec, -1
L_nocode:
  s_cmp_ge_u32 s20, 4
  s_cbranch_scc1 L_compute
  s_setprio 1
  s_and_b32 s24, s2, 7
  s_lshr_b32 s25, s2, 3
  s_and_b32 s23, s24, 1
  s_lshl_b32 s23, s23, 2
  s_and_b32 s26, s25, 3
  s_add_u32 s23, s23, s26
  s_lshr_b32 s21, s25, 4
  s_lshr_b32 s22, s24, 1
  s_lshl_b32 s22, s22, 2
  s_bfe_u32 s26, s25, 0x20002
  s_add_u32 s22, s22, s26
  v_lshrrev_b32 v2, 3, v1
  s_lshl_b32 s24, s20, 6
  v_add_u32 v2, s24, v2
  v_mul_u32_u24 v2, 1280, v2
  v_lshrrev_b32 v3, 4, v1
  v_and_b32 v4, 7, v1
  v_xor_b32 v4, v3, v4
  v_lshl_add_u32 v6, v4, 4, v2
  v_xor_b32 v7, 64, v6
  v_add_u32 v7, 9216, v7
  v_add_u32 v8, 18432, v6
  v_add_u32 v9, 18432, v7
  s_mul_i32 s28, s20, 24576
  s_lshr_b32 s24, s22, 2
  s_xor_b32 s24, s24, s22
  s_and_b32 s58, s24, 1
  s_mul_i32 s64, s23, 327680
  s_mov_b32 s6, 327680
  s_mov_b32 s7, 0x20000
  s_mov_b32 s10, 2457600
  s_mov_b32 s11, 0x20000
  s_lshl_b32 s24, s20, 4
  s_add_u32 s24, s24, s22
  s_mov_b32 s66, 0xa5a5566a
  s_mov_b32 s67, 0
  s_bitcmp0_b64 s[66:67], s24
  s_cbranch_scc1 L_lt0
  s_lshr_b32 s24, s22, 2
  s_xor_b32 s24, s24, s22
  s_and_b32 s58, s24, 1
  s_lshr_b32 s25, s22, 1
  s_lshl_b32 s26, s21, 3
  s_add_u32 s26, s26, s25
  s_lshl_b32 s26, s26, 4
  v_lshrrev_b32 v2, 1, v1
  v_add_u32 v2, s26, v2
  v_mul_u32_u24 v2, 1280, v2
  v_and_b32 v3, 1, v1
  v_lshl_add_u32 v36, v3, 7, v2
  s_and_b32 s25, s25, 1
  s_lshl_b32 s26, s23, 1
  s_add_u32 s26, s26, s25
  s_lshl_b32 s26, s26, 2
  v_mul_u32_u24 v3, 57, v1
  v_lshrrev_b32 v3, 9, v3
  v_mul_u32_u24 v4, 9, v3
  v_sub_u32 v4, v1, v4
  v_add_u32 v3, s26, v3
  v_mul_u32_u24 v3, 3840, v3
  v_mul_u32_u24 v5, 11, v4
  v_lshrrev_b32 v5, 5, v5
  v_mul_u32_u24 v5, 896, v5
  v_lshl_add_u32 v4, v4, 7, v5
  v_add_u32 v3, v3, v4
  s_lshr_b32 s26, s22, 2
  s_mul_i32 s26, s26, 320
  s_and_b32 s26, s26, 0xffffff80
  v_add_u32 v37, s26, v3
  s_mul_i32 s24, s20, 491520
  v_add_u32 v37, s24, v37
  s_lshl_b32 s24, s20, 8
  v_add_u32 v36, s24, v36
  s_cmp_eq_u32 s21, 0
  s_waitcnt lgkmcnt(0)
  s_cselect_b32 s8, s46, s38
  s_cselect_b32 s9, s47, s39
  s_add_u32 s4, s36, s64
  s_addc_u32 s5, s37, 0
  s_mov_b32 exec_hi, 0xf
  s_mov_b32 s35, 0
  buffer_load_dword v167, v37, s[8:11], s35 offen
  s_mov_b32 s34, 245760
  buffer_load_dword v167, v37, s[8:11], s34 offen
  s_mov_b32 exec_lo, -1
  s_mov_b32 exec_hi, 0
  buffer_load_dword v167, v36, s[4:7], 0 offen offset:0
  s_mov_b64 exec, -1
L_lt0:
  s_cmp_eq_u32 s21, 0
  s_waitcnt lgkmcnt(0)
  s_cselect_b32 s8, s46, s38
  s_cselect_b32 s9, s47, s39
  s_add_u32 s4, s36, s64
  s_addc_u32 s5, s37, 0
L_lt:
  s_add_u32 m0, s28, 0
  s_mov_b32 s34, 0
  buffer_load_dwordx4 v6, s[4:7], s34 offen offset:0  lds
  buffer_load_dwordx4 v7, s[4:7], s34 offen offset:1024  lds
  buffer_load_dwordx4 v8, s[4:7], s34 offen offset:2048  lds
  buffer_load_dwordx4 v9, s[4:7], s34 offen offset:3072  lds
  s_add_u32 m0, s28, 12288
  s_mov_b32 s34, 40960
  buffer_load_dwordx4 v6, s[4:7], s34 offen offset:0  lds
  buffer_load_dwordx4 v7, s[4:7], s34 offen offset:1024  lds
  buffer_load_dwordx4 v8, s[4:7], s34 offen offset:2048  lds
  buffer_load_dwordx4 v9, s[4:7], s34 offen offset:3072  lds
  s_load_dwordx4 s[52:55], s[0:1], 64
  s_load_dwordx2 s[56:57], s[0:1], 80
  s_mov_b32 s16, s50
  s_mov_b32 s17, s51
  s_mov_b32 s18, 1280
  s_mov_b32 s19, 0x20000
  s_xor_b32 s76, s21, 1
  s_lshl_b32 s76, s76, 4
  s_add_u32 s76, s76, s22
  s_lshl_b32 s64, s76, 12
  s_cmp_eq_u32 s21, 0
  s_cselect_b32 s65, 9, 7
  s_lshl_b32 s65, s23, s65
  s_add_u32 s64, s64, s65
  s_add_u32 s73, s64, 14680064
  s_lshr_b32 s64, s76, 4
  s_lshl_b32 s64, s64, 3
  s_add_u32 s64, s64, s23
  s_lshl_b32 s64, s64, 5
  s_add_u32 s64, s64, s22
  s_lshl_b32 s64, s64, 7
  s_add_u32 s3, s64, 14811136
  s_and_b32 s96, s2, 7
  s_lshl_b32 s96, s96, 2
  s_lshr_b32 s24, s2, 6
  s_add_u32 s96, s96, s24
  s_bfe_u32 s97, s2, 0x30003
  s_and_b32 s67, s76, 30
  s_and_b32 s24, s23, 1
  s_add_u32 s67, s67, s24
  s_and_b32 s64, s67, 15
  s_mul_i32 s64, s64, 51200
  s_lshr_b32 s66, s23, 1
  s_mul_i32 s65, s66, 320
  s_add_u32 s64, s64, s65
  s_mul_i32 s65, s20, 200
  v_add_u32 v4, s65, v1
  v_add_u32 v2, 0, v4
  v_mul_u32_u24 v3, 3277, v2
  v_lshrrev_b32 v3, 16, v3
  v_mul_u32_u24 v3, 960, v3
  v_lshl_add_u32 v3, v4, 4, v3
  v_add_u32 v20, s64, v3
  v_add_u32 v2, 64, v4
  v_mul_u32_u24 v3, 3277, v2
  v_lshrrev_b32 v3, 16, v3
  v_mul_u32_u24 v3, 960, v3
  v_lshl_add_u32 v3, v4, 4, v3
  v_add_u32 v21, s64, v3
  v_add_u32 v2, 128, v4
  v_mul_u32_u24 v3, 3277, v2
  v_lshrrev_b32 v3, 16, v3
  v_mul_u32_u24 v3, 960, v3
  v_lshl_add_u32 v3, v4, 4, v3
  v_add_u32 v22, s64, v3
  v_add_u32 v2, 192, v4
  v_mul_u32_u24 v3, 3277, v2
  v_lshrrev_b32 v3, 16, v3
  v_mul_u32_u24 v3, 960, v3
  v_lshl_add_u32 v3, v4, 4, v3
  v_add_u32 v23, s64, v3
  v_lshrrev_b32 v2, 5, v1
  v_bfe_u32 v3, v1, 2, 3
  v_mad_u32_u24 v2, v2, 24, v3
  v_mul_u32_u24 v2, 320, v2
  v_and_b32 v4, 3, v1
  v_lshlrev_b32 v4, 3, v4
  v_add_u32 v4, 147456, v4
  v_add_u32 v2, v4, v2
  s_lshl_b32 s65, s20, 5
  v_add_u32 v24, s65, v2
  v_add_u32 v25, 2560, v24
  v_add_u32 v26, 128, v2
  v_add_u32 v27, 2560, v26
  s_lshr_b32 s64, s67, 2
  s_mul_i32 s64, s64, 25600
  s_mul_i32 s66, s66, 409600
  s_add_u32 s64, s64, s66
  s_add_u32 s72, s64, 16777216
  s_and_b32 s66, s67, 3
  s_mul_i32 s64, s66, 5120
  v_lshl_add_u32 v3, v1, 4, s64
  s_lshl_b32 s65, s20, 10
  v_add_u32 v28, s65, v3
  v_add_u32 v29, 4096, v3
  s_cmp_eq_u32 s20, 0
  s_cbranch_scc1 L_pk0
  v_lshrrev_b32 v2, 4, v1
  s_cmp_eq_u32 s20, 1
  s_cbranch_scc1 L_pk1
  v_mov_b32 v2, 4
L_pk1:
  v_bfe_u32 v3, v1, 2, 2
  v_mul_u32_u24 v3, 320, v3
  v_add_u32 v3, v4, v3
  v_lshl_add_u32 v3, v2, 5, v3
  v_add_u32 v26, 5120, v3
  v_add_u32 v27, 6400, v3
  s_lshl_b32 s64, s66, 8
  s_add_u32 s64, s64, 20480
  v_and_b32 v3, 15, v1
  v_lshl_add_u32 v3, v3, 4, s64
  v_lshl_add_u32 v29, v2, 10, v3
L_pk0:
  s_cmp_eq_u32 s21, 0
  s_cselect_b32 s60, s48, s42
  s_cselect_b32 s61, s49, s43
  s_mov_b32 s62, 819200
  s_mov_b32 s63, 0x20000
  v_lshrrev_b32 v3, 4, v1
  s_lshl_b32 s24, s20, 4
  s_mul_i32 s25, s22, 80
  v_add_u32 v5, s24, v3
  v_mul_u32_u24 v5, 3840, v5
  v_add_u32 v5, s25, v5
  v_and_b32 v2, 15, v1
  v_lshlrev_b32 v3, 1, v3
  v_xor_b32 v2, v2, v3
  v_mul_u32_u24 v4, 13, v2
  v_lshrrev_b32 v4, 6, v4
  v_mul_u32_u24 v4, 1200, v4
  v_lshl_add_u32 v4, v2, 4, v4
  v_add_u32 v10, v4, v5
  v_add_u32 v11, 14336, v10
  v_xor_b32 v2, 8, v2
  v_mul_u32_u24 v4, 13, v2
  v_lshrrev_b32 v4, 6, v4
  v_mul_u32_u24 v4, 1200, v4
  v_lshl_add_u32 v4, v2, 4, v4
  v_add_u32 v4, v4, v5
  v_add_u32 v12, 28672, v4
  v_add_u32 v13, 43008, v4
  s_lshl_b32 s29, s20, 12
  s_add_u32 s29, s29, 98304
  s_mov_b32 s30, 0xdfff7fff
  s_mov_b32 s31, 0xfdfff7ff
  s_mov_b32 s32, 0xffdfff7f
  s_mov_b32 s33, 0xfffdfff7
  v_lshrrev_b32 v2, 4, v1
  v_and_b32 v3, 15, v1
  v_add_u32 v3, s24, v3
  v_lshl_add_u32 v2, v2, 6, v3
  v_lshlrev_b32 v5, 1, v2
  v_and_b32 v4, 3, v1
  v_bfe_u32 v2, v1, 3, 1
  v_lshl_add_u32 v4, v2, 2, v4
  v_xor_b32 v4, 7, v4
  v_lshlrev_b32 v4, 5, v4
  v_lshl_add_u32 v14, v3, 8, v4
  v_add_u32 v14, 98320, v14
  s_waitcnt lgkmcnt(0)
  s_mov_b32 s12, s56
  s_mov_b32 s13, s57
  s_mov_b32 s14, 268435456
  s_mov_b32 s15, 0x20000
  v_mov_b32 v41, 0
  v_mov_b32 v42, 0
  v_mov_b32 v43, 0
  buffer_load_ushort v15, v5, s[16:19], 0 offen offset:0
  buffer_load_ushort v16, v5, s[16:19], 0 offen offset:512
  buffer_load_ushort v17, v5, s[16:19], 0 offen offset:1024
  s_add_u32 m0, s29, 0
  s_mov_b32 s35, 0
  s_mov_b64 exec, s[30:31]
  buffer_load_dwordx4 v10, s[8:11], s35 offen offset:0  lds
  buffer_load_dwordx4 v11, s[8:11], s35 offen offset:1024  lds
  s_mov_b64 exec, s[32:33]
  buffer_load_dwordx4 v12, s[8:11], s35 offen offset:2048  lds
  buffer_load_dwordx4 v13, s[8:11], s35 offen offset:3072  lds
  s_mov_b64 exec, -1
  s_add_u32 m0, s29, 16384
  s_mov_b32 s35, 245760
  s_mov_b64 exec, s[30:31]
  buffer_load_dwordx4 v10, s[8:11], s35 offen offset:0  lds
  buffer_load_dwordx4 v11, s[8:11], s35 offen offset:1024  lds
  s_mov_b64 exec, s[32:33]
  buffer_load_dwordx4 v12, s[8:11], s35 offen offset:2048  lds
  buffer_load_dwordx4 v13, s[8:11], s35 offen offset:3072  lds
  s_mov_b64 exec, -1
  s_add_u32 m0, s28, 4096
  s_mov_b32 s34, 128
  buffer_load_dwordx4 v6, s[4:7], s34 offen offset:0  lds
  buffer_load_dwordx4 v7, s[4:7], s34 offen offset:1024  lds
  s_waitcnt vmcnt(10)
  v_mov_b32 v40, v15
  s_mov_b32 exec_lo, 0xffff
  s_mov_b32 exec_hi, 0x0
  ds_write_b128 v14, v[40:43] offset:0
  s_mov_b64 exec, -1
  s_mov_b32 exec_lo, 0xffff0000
  s_mov_b32 exec_hi, 0x0
  ds_write_b128 v14, v[40:43] offset:16384
  s_mov_b64 exec, -1
  s_mov_b32 exec_lo, 0x0
  s_mov_b32 exec_hi, 0xffff
  ds_write_b128 v14, v[40:43] offset:32768
  s_mov_b64 exec, -1
  s_waitcnt vmcnt(6) lgkmcnt(0)
  s_barrier
  buffer_load_dwordx4 v8, s[4:7], s34 offen offset:2048  lds
  buffer_load_dwordx4 v9, s[4:7], s34 offen offset:3072  lds
  s_add_u32 m0, s28, 16384
  s_mov_b32 s34, 41088
  buffer_load_dwordx4 v6, s[4:7], s34 offen offset:0  lds
  buffer_load_dwordx4 v7, s[4:7], s34 offen offset:1024  lds
  buffer_load_dwordx4 v8, s[4:7], s34 offen offset:2048  lds
  buffer_load_dwordx4 v9, s[4:7], s34 offen offset:3072  lds
  s_add_u32 m0, s29, 32768
  s_mov_b32 s35, 491520
  s_mov_b64 exec, s[30:31]
  buffer_load_dwordx4 v10, s[8:11], s35 offen offset:0  lds
  buffer_load_dwordx4 v11, s[8:11], s35 offen offset:1024  lds
  s_mov_b64 exec, s[32:33]
  buffer_load_dwordx4 v12, s[8:11], s35 offen offset:2048  lds
  buffer_load_dwordx4 v13, s[8:11], s35 offen offset:3072  lds
  s_mov_b64 exec, -1
  s_add_u32 m0, s28, 8192
  s_mov_b32 s34, 256
  buffer_load_dwordx4 v6, s[4:7], s34 offen offset:0  lds
  buffer_load_dwordx4 v7, s[4:7], s34 offen offset:1024  lds
  s_waitcnt vmcnt(6) lgkmcnt(0)
  s_barrier
  buffer_load_dwordx4 v8, s[4:7], s34 offen offset:2048  lds
  buffer_load_dwordx4 v9, s[4:7], s34 offen offset:3072  lds
  s_add_u32 m0, s28, 20480
  s_mov_b32 s34, 41216
  buffer_load_dwordx4 v6, s[4:7], s34 offen offset:0  lds
  buffer_load_dwordx4 v7, s[4:7], s34 offen offset:1024  lds
  buffer_load_dwordx4 v8, s[4:7], s34 offen offset:2048  lds
  buffer_load_dwordx4 v9, s[4:7], s34 offen offset:3072  lds
  s_mov_b32 exec_lo, 0x0
  s_mov_b32 exec_hi, 0xffff0000
  ds_write_b16 v14, v15 offset:0
  s_mov_b64 exec, -1
  s_add_u32 m0, s29, 0
  s_mov_b32 s35, 737280
  s_mov_b64 exec, s[30:31]
  buffer_load_dwordx4 v10, s[8:11], s35 offen offset:0  lds
  buffer_load_dwordx4 v11, s[8:11], s35 offen offset:1024  lds
  s_mov_b64 exec, s[32:33]
  buffer_load_dwordx4 v12, s[8:11], s35 offen offset:2048  lds
  buffer_load_dwordx4 v13, s[8:11], s35 offen offset:3072  lds
  s_mov_b64 exec, -1
  s_add_u32 m0, s28, 0
  s_mov_b32 s34, 384
  buffer_load_dwordx4 v6, s[4:7], s34 offen offset:0  lds
  buffer_load_dwordx4 v7, s[4:7], s34 offen offset:1024  lds
  s_waitcnt vmcnt(6) lgkmcnt(0)
  s_barrier
  buffer_load_dwordx4 v8, s[4:7], s34 offen offset:2048  lds
  buffer_load_dwordx4 v9, s[4:7], s34 offen offset:3072  lds
  s_add_u32 m0, s28, 12288
  s_mov_b32 s34, 41344
  buffer_load_dwordx4 v6, s[4:7], s34 offen offset:0  lds
  buffer_load_dwordx4 v7, s[4:7], s34 offen offset:1024  lds
  buffer_load_dwordx4 v8, s[4:7], s34 offen offset:2048  lds
  buffer_load_dwordx4 v9, s[4:7], s34 offen offset:3072  lds
  s_cmp_lg_u32 s58, 0
  s_cbranch_scc1 L_nopd
  s_mul_i32 s65, s20, 3200
  s_add_u32 m0, s65, 147456
  s_nop 0
  buffer_load_dwordx4 v20, s[60:63], 0 offen offset:0 lds
  buffer_load_dwordx4 v21, s[60:63], 0 offen offset:1024 lds
  buffer_load_dwordx4 v22, s[60:63], 0 offen offset:2048 lds
  s_mov_b64 exec, 0xff
  buffer_load_dwordx4 v23, s[60:63], 0 offen offset:3072 lds
  s_mov_b64 exec, -1
L_nopd:
  s_mov_b32 exec_lo, 0xffff
  s_mov_b32 exec_hi, 0x0
  ds_write_b16 v14, v16 offset:16384
  s_mov_b64 exec, -1
  s_add_u32 m0, s29, 16384
  s_mov_b32 s35, 983040
  s_mov_b64 exec, s[30:31]
  buffer_load_dwordx4 v10, s[8:11], s35 offen offset:0  lds
  buffer_load_dwordx4 v11, s[8:11], s35 offen offset:1024  lds
  s_mov_b64 exec, s[32:33]
  buffer_load_dwordx4 v12, s[8:11], s35 offen offset:2048  lds
  buffer_load_dwordx4 v13, s[8:11], s35 offen offset:3072  lds
  s_mov_b64 exec, -1
  s_add_u32 m0, s28, 4096
  s_mov_b32 s34, 512
  buffer_load_dwordx4 v6, s[4:7], s34 offen offset:0  lds
  buffer_load_dwordx4 v7, s[4:7], s34 offen offset:1024  lds
  s_waitcnt vmcnt(6) lgkmcnt(0)
  s_barrier
  buffer_load_dwordx4 v8, s[4:7], s34 offen offset:2048  lds
  buffer_load_dwordx4 v9, s[4:7], s34 offen offset:3072  lds
  s_add_u32 m0, s28, 16384
  s_mov_b32 s34, 41472
  buffer_load_dwordx4 v6, s[4:7], s34 offen offset:0  lds
  buffer_load_dwordx4 v7, s[4:7], s34 offen offset:1024  lds
  buffer_load_dwordx4 v8, s[4:7], s34 offen offset:2048  lds
  buffer_load_dwordx4 v9, s[4:7], s34 offen offset:3072  lds
  s_cmp_lg_u32 s58, 0
  s_cbranch_scc1 L_nops
  ds_read_b64_tr_b16 v[44:45], v24 offset:0
  ds_read_b64_tr_b16 v[46:47], v25 offset:0
  ds_read_b64_tr_b16 v[48:49], v26 offset:0
  ds_read_b64_tr_b16 v[50:51], v27 offset:0
  ds_read_b64_tr_b16 v[52:53], v24 offset:160
  ds_read_b64_tr_b16 v[54:55], v25 offset:160
  ds_read_b64_tr_b16 v[56:57], v26 offset:160
  ds_read_b64_tr_b16 v[58:59], v27 offset:160
  s_add_u32 s64, s72, 204800
  s_waitcnt lgkmcnt(6)
  buffer_store_dwordx4 v[44:47], v28, s[12:15], s72 offen sc1
  s_waitcnt lgkmcnt(2)
  buffer_store_dwordx4 v[52:55], v28, s[12:15], s64 offen sc1
  s_cmp_lt_u32 s20, 2
  s_cselect_b64 exec, -1, 0xffff
  s_waitcnt lgkmcnt(0)
  buffer_store_dwordx4 v[48:51], v29, s[12:15], s72 offen sc1
  buffer_store_dwordx4 v[56:59], v29, s[12:15], s64 offen sc1
  s_mov_b64 exec, -1
L_nops:
  s_mov_b32 exec_lo, 0xffff0000
  s_mov_b32 exec_hi, 0x0
  ds_write_b16 v14, v16 offset:32768
  s_mov_b64 exec, -1
  s_add_u32 m0, s29, 32768
  s_mov_b32 s35, 1228800
  s_mov_b64 exec, s[30:31]
  buffer_load_dwordx4 v10, s[8:11], s35 offen offset:0  lds
  buffer_load_dwordx4 v11, s[8:11], s35 offen offset:1024  lds
  s_mov_b64 exec, s[32:33]
  buffer_load_dwordx4 v12, s[8:11], s35 offen offset:2048  lds
  buffer_load_dwordx4 v13, s[8:11], s35 offen offset:3072  lds
  s_mov_b64 exec, -1
  s_add_u32 m0, s28, 8192
  s_mov_b32 s34, 640
  buffer_load_dwordx4 v6, s[4:7], s34 offen offset:0  lds
  buffer_load_dwordx4 v7, s[4:7], s34 offen offset:1024  lds
  s_waitcnt vmcnt(10) lgkmcnt(0)
  s_cmp_lg_u32 s58, 1
  s_cbranch_scc1 L_pkw
  s_waitcnt vmcnt(6)
L_pkw:
  s_barrier
  buffer_load_dwordx4 v8, s[4:7], s34 offen offset:2048  lds
  buffer_load_dwordx4 v9, s[4:7], s34 offen offset:3072  lds
  s_add_u32 m0, s28, 20480
  s_mov_b32 s34, 41600
  buffer_load_dwordx4 v6, s[4:7], s34 offen offset:0  lds
  buffer_load_dwordx4 v7, s[4:7], s34 offen offset:1024  lds
  buffer_load_dwordx4 v8, s[4:7], s34 offen offset:2048  lds
  buffer_load_dwordx4 v9, s[4:7], s34 offen offset:3072  lds
  s_mov_b32 exec_lo, 0x0
  s_mov_b32 exec_hi, 0xffff
  ds_write_b16 v14, v16 offset:0
  s_mov_b64 exec, -1
  s_add_u32 m0, s29, 0
  s_mov_b32 s35, 1474560
  s_mov_b64 exec, s[30:31]
  buffer_load_dwordx4 v10, s[8:11], s35 offen offset:0  lds
  buffer_load_dwordx4 v11, s[8:11], s35 offen offset:1024  lds
  s_mov_b64 exec, s[32:33]
  buffer_load_dwordx4 v12, s[8:11], s35 offen offset:2048  lds
  buffer_load_dwordx4 v13, s[8:11], s35 offen offset:3072  lds
  s_mov_b64 exec, -1
  s_add_u32 m0, s28, 0
  s_mov_b32 s34, 768
  buffer_load_dwordx4 v6, s[4:7], s34 offen offset:0  lds
  buffer_load_dwordx4 v7, s[4:7], s34 offen offset:1024  lds
  s_waitcnt vmcnt(6) lgkmcnt(0)
  s_barrier
  buffer_load_dwordx4 v8, s[4:7], s34 offen offset:2048  lds
  buffer_load_dwordx4 v9, s[4:7], s34 offen offset:3072  lds
  s_add_u32 m0, s28, 12288
  s_mov_b32 s34, 41728
  buffer_load_dwordx4 v6, s[4:7], s34 offen offset:0  lds
  buffer_load_dwordx4 v7, s[4:7], s34 offen offset:1024  lds
  buffer_load_dwordx4 v8, s[4:7], s34 offen offset:2048  lds
  buffer_load_dwordx4 v9, s[4:7], s34 offen offset:3072  lds
  s_mov_b32 exec_lo, 0x0
  s_mov_b32 exec_hi, 0xffff0000
  ds_write_b16 v14, v16 offset:16384
  s_mov_b64 exec, -1
  s_add_u32 m0, s29, 16384
  s_mov_b32 s35, 1720320
  s_mov_b64 exec, s[30:31]
  buffer_load_dwordx4 v10, s[8:11], s35 offen offset:0  lds
  buffer_load_dwordx4 v11, s[8:11], s35 offen offset:1024  lds
  s_mov_b64 exec, s[32:33]
  buffer_load_dwordx4 v12, s[8:11], s35 offen offset:2048  lds
  buffer_load_dwordx4 v13, s[8:11], s35 offen offset:3072  lds
  s_mov_b64 exec, -1
  s_add_u32 m0, s28, 4096
  s_mov_b32 s34, 896
  buffer_load_dwordx4 v6, s[4:7], s34 offen offset:0  lds
  buffer_load_dwordx4 v7, s[4:7], s34 offen offset:1024  lds
  s_waitcnt vmcnt(6) lgkmcnt(0)
  s_barrier
  buffer_load_dwordx4 v8, s[4:7], s34 offen offset:2048  lds
  buffer_load_dwordx4 v9, s[4:7], s34 offen offset:3072  lds
  s_add_u32 m0, s28, 16384
  s_mov_b32 s34, 41856
  buffer_load_dwordx4 v6, s[4:7], s34 offen offset:0  lds
  buffer_load_dwordx4 v7, s[4:7], s34 offen offset:1024  lds
  buffer_load_dwordx4 v8, s[4:7], s34 offen offset:2048  lds
  buffer_load_dwordx4 v9, s[4:7], s34 offen offset:3072  lds
  s_mov_b32 exec_lo, 0xffff
  s_mov_b32 exec_hi, 0x0
  ds_write_b16 v14, v17 offset:32768
  s_mov_b64 exec, -1
  s_add_u32 m0, s29, 32768
  s_mov_b32 s35, 1966080
  s_mov_b64 exec, s[30:31]
  buffer_load_dwordx4 v10, s[8:11], s35 offen offset:0  lds
  buffer_load_dwordx4 v11, s[8:11], s35 offen offset:1024  lds
  s_mov_b64 exec, s[32:33]
  buffer_load_dwordx4 v12, s[8:11], s35 offen offset:2048  lds
  buffer_load_dwordx4 v13, s[8:11], s35 offen offset:3072  lds
  s_mov_b64 exec, -1
  s_add_u32 m0, s28, 8192
  s_mov_b32 s34, 1024
  buffer_load_dwordx4 v6, s[4:7], s34 offen offset:0  lds
  buffer_load_dwordx4 v7, s[4:7], s34 offen offset:1024  lds
  s_waitcnt vmcnt(6) lgkmcnt(0)
  s_barrier
  buffer_load_dwordx4 v8, s[4:7], s34 offen offset:2048  lds
  buffer_load_dwordx4 v9, s[4:7], s34 offen offset:3072  lds
  s_add_u32 m0, s28, 20480
  s_mov_b32 s34, 41984
  buffer_load_dwordx4 v6, s[4:7], s34 offen offset:0  lds
  buffer_load_dwordx4 v7, s[4:7], s34 offen offset:1024  lds
  buffer_load_dwordx4 v8, s[4:7], s34 offen offset:2048  lds
  buffer_load_dwordx4 v9, s[4:7], s34 offen offset:3072  lds
  s_mov_b32 exec_lo, 0xffff0000
  s_mov_b32 exec_hi, 0x0
  ds_write_b16 v14, v17 offset:0
  s_mov_b64 exec, -1
  s_add_u32 m0, s29, 0
  s_mov_b32 s35, 2211840
  s_mov_b64 exec, s[30:31]
  buffer_load_dwordx4 v10, s[8:11], s35 offen offset:0  lds
  buffer_load_dwordx4 v11, s[8:11], s35 offen offset:1024  lds
  s_mov_b64 exec, s[32:33]
  buffer_load_dwordx4 v12, s[8:11], s35 offen offset:2048  lds
  buffer_load_dwordx4 v13, s[8:11], s35 offen offset:3072  lds
  s_mov_b64 exec, -1
  s_add_u32 m0, s28, 0
  s_mov_b32 s34, 1152
  buffer_load_dwordx4 v6, s[4:7], s34 offen offset:0  lds
  buffer_load_dwordx4 v7, s[4:7], s34 offen offset:1024  lds
  s_waitcnt vmcnt(6) lgkmcnt(0)
  s_barrier
  buffer_load_dwordx4 v8, s[4:7], s34 offen offset:2048  lds
  buffer_load_dwordx4 v9, s[4:7], s34 offen offset:3072  lds
  s_add_u32 m0, s28, 12288
  s_mov_b32 s34, 42112
  buffer_load_dwordx4 v6, s[4:7], s34 offen offset:0  lds
  buffer_load_dwordx4 v7, s[4:7], s34 offen offset:1024  lds
  buffer_load_dwordx4 v8, s[4:7], s34 offen offset:2048  lds
  buffer_load_dwordx4 v9, s[4:7], s34 offen offset:3072  lds
  s_waitcnt vmcnt(0) lgkmcnt(0)
  s_barrier
  v_mov_b32 v2, 163816
  ds_read_b64 v[4:5], v2
  s_waitcnt lgkmcnt(0)
  v_readfirstlane_b32 s100, v4
  v_readfirstlane_b32 s101, v5
  s_cmp_eq_u32 s21, 0
  s_cselect_b32 s30, 0, 112384
  s_cselect_b32 s31, 102400, 0
  v_lshlrev_b32 v16, 4, v1
  v_lshlrev_b32 v17, 3, v1
  s_lshl_b32 s29, s20, 10
  v_add_u32 v14, s29, v16
  s_mul_i32 s71, s97, 204800
  s_add_u32 s71, s71, 16777216
  s_add_u32 s30, s30, s29
  s_add_u32 s31, s31, s29
  s_setprio 0
  s_cmp_eq_u32 s21, 0
  s_cbranch_scc0 L_loadA
  s_add_u32 s24, s71, 102400
  buffer_load_dwordx4 v[68:71], v14, s[12:15], s24 offen sc1
  s_add_u32 s24, s71, 106496
  buffer_load_dwordx4 v[72:75], v14, s[12:15], s24 offen sc1
  s_add_u32 s24, s71, 110592
  buffer_load_dwordx4 v[76:79], v14, s[12:15], s24 offen sc1
  s_add_u32 s24, s71, 114688
  buffer_load_dwordx4 v[80:83], v14, s[12:15], s24 offen sc1
  s_add_u32 s24, s71, 118784
  buffer_load_dwordx4 v[84:87], v14, s[12:15], s24 offen sc1
  s_add_u32 s24, s71, 122880
  buffer_load_dwordx4 v[88:91], v14, s[12:15], s24 offen sc1
  s_add_u32 s24, s71, 126976
  buffer_load_dwordx4 v[92:95], v14, s[12:15], s24 offen sc1
  s_add_u32 s24, s71, 131072
  buffer_load_dwordx4 v[96:99], v14, s[12:15], s24 offen sc1
  s_add_u32 s24, s71, 135168
  buffer_load_dwordx4 v[100:103], v14, s[12:15], s24 offen sc1
  s_add_u32 s24, s71, 139264
  buffer_load_dwordx4 v[104:107], v14, s[12:15], s24 offen sc1
  s_add_u32 s24, s71, 143360
  buffer_load_dwordx4 v[108:111], v14, s[12:15], s24 offen sc1
  s_add_u32 s24, s71, 147456
  buffer_load_dwordx4 v[112:115], v14, s[12:15], s24 offen sc1
  s_add_u32 s24, s71, 151552
  buffer_load_dwordx4 v[116:119], v14, s[12:15], s24 offen sc1
  s_setprio 1
  s_mul_i32 s66, s20, 10496
  s_add_u32 s64, s66, 121600
  v_add_u32 v3, s64, v16
  s_lshl_b32 s65, s22, 3
  s_add_u32 s65, s65, s23
  s_mul_i32 s65, s65, 41984
  s_add_u32 s65, s65, s66
  s_add_u32 s65, s65, 6291456
  s_lshl_b32 s64, s20, 7
  s_add_u32 s73, s73, s64
  s_barrier
  ds_read_b128 v[20:23], v3 offset:0
  ds_read_b128 v[24:27], v3 offset:1024
  ds_read_b128 v[28:31], v3 offset:2048
  ds_read_b128 v[32:35], v3 offset:3072
  ds_read_b128 v[36:39], v3 offset:4096
  ds_read_b128 v[40:43], v3 offset:5120
  ds_read_b128 v[44:47], v3 offset:6144
  ds_read_b128 v[48:51], v3 offset:7168
  ds_read_b128 v[52:55], v3 offset:8192
  ds_read_b128 v[56:59], v3 offset:9216
  s_mov_b64 exec, 0xffff
  ds_read_b128 v[60:63], v3 offset:10240
  s_mov_b64 exec, -1
  s_add_u32 s67, s65, 0
  s_waitcnt lgkmcnt(10)
  buffer_store_dwordx4 v[20:23], v16, s[12:15], s67 offen sc1
  s_add_u32 s67, s65, 1024
  s_waitcnt lgkmcnt(9)
  buffer_store_dwordx4 v[24:27], v16, s[12:15], s67 offen sc1
  s_add_u32 s67, s65, 2048
  s_waitcnt lgkmcnt(8)
  buffer_store_dwordx4 v[28:31], v16, s[12:15], s67 offen sc1
  s_add_u32 s67, s65, 3072
  s_waitcnt lgkmcnt(7)
  buffer_store_dwordx4 v[32:35], v16, s[12:15], s67 offen sc1
  s_add_u32 s67, s65, 4096
  s_waitcnt lgkmcnt(6)
  buffer_store_dwordx4 v[36:39], v16, s[12:15], s67 offen sc1
  s_add_u32 s67, s65, 5120
  s_waitcnt lgkmcnt(5)
  buffer_store_dwordx4 v[40:43], v16, s[12:15], s67 offen sc1
  s_add_u32 s67, s65, 6144
  s_waitcnt lgkmcnt(4)
  buffer_store_dwordx4 v[44:47], v16, s[12:15], s67 offen sc1
  s_add_u32 s67, s65, 7168
  s_waitcnt lgkmcnt(3)
  buffer_store_dwordx4 v[48:51], v16, s[12:15], s67 offen sc1
  s_add_u32 s67, s65, 8192
  s_waitcnt lgkmcnt(2)
  buffer_store_dwordx4 v[52:55], v16, s[12:15], s67 offen sc1
  s_add_u32 s67, s65, 9216
  s_waitcnt lgkmcnt(1)
  buffer_store_dwordx4 v[56:59], v16, s[12:15], s67 offen sc1
  s_add_u32 s67, s65, 10240
  s_waitcnt lgkmcnt(0)
  s_mov_b64 exec, 0xffff
  buffer_store_dwordx4 v[60:63], v16, s[12:15], s67 offen sc1
  s_mov_b64 exec, -1
  v_lshlrev_b32 v2, 3, v1
  v_mov_b32 v4, s100
  v_mov_b32 v5, s101
  s_mov_b64 exec, 0x1
  s_waitcnt vmcnt(0)
  buffer_store_dwordx2 v[4:5], v2, s[12:15], s73 offen sc1
  s_mov_b64 exec, -1
  s_cmp_eq_u32 s23, 0
  s_cbranch_scc1 L_nonbr
  s_sub_u32 s64, s73, 512
  v_mov_b32 v2, 0
  s_mov_b32 s69, 1048576
  s_mov_b32 exec_lo, 0x1
  s_mov_b32 exec_hi, 0x0
L_pollB:
  buffer_load_dwordx2 v[4:5], v2, s[12:15], s64 offen sc1
  s_sub_u32 s69, s69, 1
  s_cbranch_scc1 L_pollB_out
  s_waitcnt vmcnt(0)
  v_cmp_ne_u64 vcc, s[100:101], v[4:5]
  s_nop 0
  s_and_b64 exec, exec, vcc
  s_cbranch_scc1 L_pollB
L_pollB_out:
  s_waitcnt vmcnt(0)
  s_mov_b64 exec, -1
  s_sub_u32 s65, s65, 41984
  s_add_u32 s66, s66, 51200
  s_add_u32 m0, s66, 0
  s_add_u32 s67, s65, 0
  buffer_load_dwordx4 v16, s[12:15], s67 offen sc1 lds
  s_add_u32 m0, s66, 1024
  s_add_u32 s67, s65, 1024
  buffer_load_dwordx4 v16, s[12:15], s67 offen sc1 lds
  s_add_u32 m0, s66, 2048
  s_add_u32 s67, s65, 2048
  buffer_load_dwordx4 v16, s[12:15], s67 offen sc1 lds
  s_add_u32 m0, s66, 3072
  s_add_u32 s67, s65, 3072
  buffer_load_dwordx4 v16, s[12:15], s67 offen sc1 lds
  s_add_u32 m0, s66, 4096
  s_add_u32 s67, s65, 4096
  buffer_load_dwordx4 v16, s[12:15], s67 offen sc1 lds
  s_add_u32 m0, s66, 5120
  s_add_u32 s67, s65, 5120
  buffer_load_dwordx4 v16, s[12:15], s67 offen sc1 lds
  s_add_u32 m0, s66, 6144
  s_add_u32 s67, s65, 6144
  buffer_load_dwordx4 v16, s[12:15], s67 offen sc1 lds
  s_add_u32 m0, s66, 7168
  s_add_u32 s67, s65, 7168
  buffer_load_dwordx4 v16, s[12:15], s67 offen sc1 lds
  s_add_u32 m0, s66, 8192
  s_add_u32 s67, s65, 8192
  buffer_load_dwordx4 v16, s[12:15], s67 offen sc1 lds
  s_add_u32 m0, s66, 9216
  s_add_u32 s67, s65, 9216
  buffer_load_dwordx4 v16, s[12:15], s67 offen sc1 lds
  s_add_u32 m0, s66, 10240
  s_add_u32 s67, s65, 10240
  s_mov_b64 exec, 0xffff
  buffer_load_dwordx4 v16, s[12:15], s67 offen sc1 lds
  s_mov_b64 exec, -1
L_nonbr:
  s_waitcnt vmcnt(0)
  s_barrier
  s_setprio 0
  s_waitcnt vmcnt(4)
  s_add_u32 m0, s30, 0
  s_add_u32 s24, s71, 0
  buffer_load_dwordx4 v14, s[12:15], s24 offen sc1 lds
  s_waitcnt vmcnt(4)
  s_add_u32 m0, s30, 4096
  s_add_u32 s24, s71, 4096
  buffer_load_dwordx4 v14, s[12:15], s24 offen sc1 lds
  s_waitcnt vmcnt(4)
  s_add_u32 m0, s30, 8192
  s_add_u32 s24, s71, 8192
  buffer_load_dwordx4 v14, s[12:15], s24 offen sc1 lds
  s_waitcnt vmcnt(4)
  s_add_u32 m0, s30, 12288
  s_add_u32 s24, s71, 12288
  buffer_load_dwordx4 v14, s[12:15], s24 offen sc1 lds
  s_waitcnt vmcnt(4)
  s_add_u32 m0, s30, 16384
  s_add_u32 s24, s71, 16384
  buffer_load_dwordx4 v14, s[12:15], s24 offen sc1 lds
  s_waitcnt vmcnt(4)
  s_add_u32 m0, s30, 20480
  s_add_u32 s24, s71, 20480
  buffer_load_dwordx4 v14, s[12:15], s24 offen sc1 lds
  s_waitcnt vmcnt(4)
  s_add_u32 m0, s30, 24576
  s_add_u32 s24, s71, 24576
  buffer_load_dwordx4 v14, s[12:15], s24 offen sc1 lds
  s_waitcnt vmcnt(4)
  s_add_u32 m0, s30, 28672
  s_add_u32 s24, s71, 28672
  buffer_load_dwordx4 v14, s[12:15], s24 offen sc1 lds
  s_waitcnt vmcnt(4)
  s_add_u32 m0, s30, 32768
  s_add_u32 s24, s71, 32768
  buffer_load_dwordx4 v14, s[12:15], s24 offen sc1 lds
  s_waitcnt vmcnt(4)
  s_add_u32 m0, s30, 36864
  s_add_u32 s24, s71, 36864
  buffer_load_dwordx4 v14, s[12:15], s24 offen sc1 lds
  s_waitcnt vmcnt(4)
  s_add_u32 m0, s30, 40960
  s_add_u32 s24, s71, 40960
  buffer_load_dwordx4 v14, s[12:15], s24 offen sc1 lds
  s_waitcnt vmcnt(4)
  s_add_u32 m0, s30, 45056
  s_add_u32 s24, s71, 45056
  buffer_load_dwordx4 v14, s[12:15], s24 offen sc1 lds
  s_waitcnt vmcnt(4)
  s_add_u32 s24, s30, 49152
  s_sub_u32 m0, s31, 2048
  s_cmp_lt_u32 s20, 2
  s_cselect_b32 m0, s24, m0
  s_add_u32 s24, s71, 49152
  buffer_load_dwordx4 v14, s[12:15], s24 offen sc1 lds
  s_waitcnt vmcnt(4)
  s_add_u32 m0, s31, 2048
  s_add_u32 s24, s71, 53248
  buffer_load_dwordx4 v14, s[12:15], s24 offen sc1 lds
  s_waitcnt vmcnt(4)
  s_add_u32 m0, s31, 6144
  s_add_u32 s24, s71, 57344
  buffer_load_dwordx4 v14, s[12:15], s24 offen sc1 lds
  s_waitcnt vmcnt(4)
  s_add_u32 m0, s31, 10240
  s_add_u32 s24, s71, 61440
  buffer_load_dwordx4 v14, s[12:15], s24 offen sc1 lds
  s_waitcnt vmcnt(4)
  s_add_u32 m0, s31, 14336
  s_add_u32 s24, s71, 65536
  buffer_load_dwordx4 v14, s[12:15], s24 offen sc1 lds
  s_waitcnt vmcnt(4)
  s_add_u32 m0, s31, 18432
  s_add_u32 s24, s71, 69632
  buffer_load_dwordx4 v14, s[12:15], s24 offen sc1 lds
  s_waitcnt vmcnt(4)
  s_add_u32 m0, s31, 22528
  s_add_u32 s24, s71, 73728
  buffer_load_dwordx4 v14, s[12:15], s24 offen sc1 lds
  s_waitcnt vmcnt(4)
  s_add_u32 m0, s31, 26624
  s_add_u32 s24, s71, 77824
  buffer_load_dwordx4 v14, s[12:15], s24 offen sc1 lds
  s_waitcnt vmcnt(4)
  s_add_u32 m0, s31, 30720
  s_add_u32 s24, s71, 81920
  buffer_load_dwordx4 v14, s[12:15], s24 offen sc1 lds
  s_waitcnt vmcnt(4)
  s_add_u32 m0, s31, 34816
  s_add_u32 s24, s71, 86016
  buffer_load_dwordx4 v14, s[12:15], s24 offen sc1 lds
  s_waitcnt vmcnt(4)
  s_add_u32 m0, s31, 38912
  s_add_u32 s24, s71, 90112
  buffer_load_dwordx4 v14, s[12:15], s24 offen sc1 lds
  s_waitcnt vmcnt(4)
  s_add_u32 m0, s31, 43008
  s_add_u32 s24, s71, 94208
  buffer_load_dwordx4 v14, s[12:15], s24 offen sc1 lds
  s_waitcnt vmcnt(4)
  s_add_u32 m0, s31, 47104
  s_add_u32 s24, s71, 98304
  buffer_load_dwordx4 v14, s[12:15], s24 offen sc1 lds
  s_waitcnt vmcnt(4)
  s_add_u32 s24, s71, 155648
  buffer_load_dwordx4 v[120:123], v14, s[12:15], s24 offen sc1
  s_waitcnt vmcnt(4)
  s_add_u32 s24, s71, 159744
  buffer_load_dwordx4 v[124:127], v14, s[12:15], s24 offen sc1
  s_waitcnt vmcnt(4)
  s_add_u32 s24, s71, 163840
  buffer_load_dwordx4 v[128:131], v14, s[12:15], s24 offen sc1
  s_waitcnt vmcnt(4)
  s_add_u32 s24, s71, 167936
  buffer_load_dwordx4 v[132:135], v14, s[12:15], s24 offen sc1
  s_waitcnt vmcnt(4)
  s_add_u32 s24, s71, 172032
  buffer_load_dwordx4 v[136:139], v14, s[12:15], s24 offen sc1
  s_waitcnt vmcnt(4)
  s_add_u32 s24, s71, 176128
  buffer_load_dwordx4 v[140:143], v14, s[12:15], s24 offen sc1
  s_waitcnt vmcnt(4)
  s_add_u32 s24, s71, 180224
  buffer_load_dwordx4 v[144:147], v14, s[12:15], s24 offen sc1
  s_waitcnt vmcnt(4)
  s_add_u32 s24, s71, 184320
  buffer_load_dwordx4 v[148:151], v14, s[12:15], s24 offen sc1
  s_waitcnt vmcnt(4)
  s_add_u32 s24, s71, 188416
  buffer_load_dwordx4 v[152:155], v14, s[12:15], s24 offen sc1
  s_waitcnt vmcnt(4)
  s_add_u32 s24, s71, 192512
  buffer_load_dwordx4 v[156:159], v14, s[12:15], s24 offen sc1
  s_waitcnt vmcnt(4)
  s_add_u32 s24, s71, 196608
  buffer_load_dwordx4 v[160:163], v14, s[12:15], s24 offen sc1
  s_waitcnt vmcnt(4)
  s_add_u32 s24, s71, 200704
  buffer_load_dwordx4 v[164:167], v14, s[12:15], s24 offen sc1
  s_branch L_ltail
L_loadA:
  s_add_u32 m0, s30, 4096
  s_add_u32 s24, s71, 4096
  buffer_load_dwordx4 v14, s[12:15], s24 offen sc1 lds
  s_add_u32 m0, s30, 8192
  s_add_u32 s24, s71, 8192
  buffer_load_dwordx4 v14, s[12:15], s24 offen sc1 lds
  s_add_u32 m0, s30, 12288
  s_add_u32 s24, s71, 12288
  buffer_load_dwordx4 v14, s[12:15], s24 offen sc1 lds
  s_add_u32 m0, s30, 16384
  s_add_u32 s24, s71, 16384
  buffer_load_dwordx4 v14, s[12:15], s24 offen sc1 lds
  s_add_u32 m0, s30, 20480
  s_add_u32 s24, s71, 20480
  buffer_load_dwordx4 v14, s[12:15], s24 offen sc1 lds
  s_add_u32 m0, s30, 24576
  s_add_u32 s24, s71, 24576
  buffer_load_dwordx4 v14, s[12:15], s24 offen sc1 lds
  s_add_u32 m0, s30, 28672
  s_add_u32 s24, s71, 28672
  buffer_load_dwordx4 v14, s[12:15], s24 offen sc1 lds
  s_add_u32 m0, s30, 32768
  s_add_u32 s24, s71, 32768
  buffer_load_dwordx4 v14, s[12:15], s24 offen sc1 lds
  s_add_u32 s24, s71, 102400
  buffer_load_dwordx4 v[68:71], v14, s[12:15], s24 offen sc1
  s_add_u32 s24, s71, 106496
  buffer_load_dwordx4 v[72:75], v14, s[12:15], s24 offen sc1
  s_add_u32 s24, s71, 110592
  buffer_load_dwordx4 v[76:79], v14, s[12:15], s24 offen sc1
  s_add_u32 s24, s71, 114688
  buffer_load_dwordx4 v[80:83], v14, s[12:15], s24 offen sc1
  s_add_u32 s24, s71, 118784
  buffer_load_dwordx4 v[84:87], v14, s[12:15], s24 offen sc1
  s_add_u32 s24, s71, 122880
  buffer_load_dwordx4 v[88:91], v14, s[12:15], s24 offen sc1
  s_add_u32 s24, s71, 126976
  buffer_load_dwordx4 v[92:95], v14, s[12:15], s24 offen sc1
  s_add_u32 s24, s71, 131072
  buffer_load_dwordx4 v[96:99], v14, s[12:15], s24 offen sc1
  s_add_u32 s24, s71, 135168
  buffer_load_dwordx4 v[100:103], v14, s[12:15], s24 offen sc1
  s_add_u32 s24, s71, 139264
  buffer_load_dwordx4 v[104:107], v14, s[12:15], s24 offen sc1
  s_add_u32 s24, s71, 143360
  buffer_load_dwordx4 v[108:111], v14, s[12:15], s24 offen sc1
  s_add_u32 s24, s71, 147456
  buffer_load_dwordx4 v[112:115], v14, s[12:15], s24 offen sc1
  s_add_u32 s24, s71, 151552
  buffer_load_dwordx4 v[116:119], v14, s[12:15], s24 offen sc1
  s_add_u32 s24, s71, 155648
  buffer_load_dwordx4 v[120:123], v14, s[12:15], s24 offen sc1
  s_add_u32 s24, s71, 159744
  buffer_load_dwordx4 v[124:127], v14, s[12:15], s24 offen sc1
  s_add_u32 s24, s71, 163840
  buffer_load_dwordx4 v[128:131], v14, s[12:15], s24 offen sc1
  s_add_u32 s24, s71, 167936
  buffer_load_dwordx4 v[132:135], v14, s[12:15], s24 offen sc1
  s_add_u32 s24, s71, 172032
  buffer_load_dwordx4 v[136:139], v14, s[12:15], s24 offen sc1
  s_add_u32 s24, s71, 176128
  buffer_load_dwordx4 v[140:143], v14, s[12:15], s24 offen sc1
  s_add_u32 s24, s71, 180224
  buffer_load_dwordx4 v[144:147], v14, s[12:15], s24 offen sc1
  s_add_u32 s24, s71, 184320
  buffer_load_dwordx4 v[148:151], v14, s[12:15], s24 offen sc1
  s_add_u32 s24, s71, 188416
  buffer_load_dwordx4 v[152:155], v14, s[12:15], s24 offen sc1
  s_add_u32 s24, s71, 192512
  buffer_load_dwordx4 v[156:159], v14, s[12:15], s24 offen sc1
  s_add_u32 s24, s71, 196608
  buffer_load_dwordx4 v[160:163], v14, s[12:15], s24 offen sc1
  s_add_u32 s24, s71, 200704
  buffer_load_dwordx4 v[164:167], v14, s[12:15], s24 offen sc1
  s_setprio 1
  v_lshrrev_b32 v2, 5, v1
  v_mul_u32_u24 v2, 336, v2
  v_and_b32 v3, 31, v1
  v_min_u32 v3, 20, v3
  v_lshl_add_u32 v12, v3, 4, v2
  s_and_b32 s65, s20, 1
  s_lshr_b32 s66, s20, 1
  s_mul_i32 s64, s65, 1344
  s_add_u32 s64, s64, 4096
  v_add_u32 v12, s64, v12
  v_lshrrev_b32 v5, 5, v1
  v_bfe_u32 v3, v1, 2, 2
  v_lshl_add_u32 v2, v5, 2, v3
  s_cmp_eq_u32 s66, 0
  s_cbranch_scc0 L_kv_t1
  s_lshl_b32 s64, s65, 11
  s_add_u32 s64, s64, 7168
  v_and_b32 v3, 1, v1
  v_bfe_u32 v4, v1, 4, 1
  v_lshl_add_u32 v3, v3, 1, v4
  v_lshrrev_b32 v4, 1, v2
  v_xor_b32 v3, v3, v4
  v_lshlrev_b32 v3, 4, v3
  v_lshl_add_u32 v3, v2, 6, v3
  v_bfe_u32 v4, v1, 1, 1
  v_lshl_add_u32 v3, v4, 3, v3
  v_add_u32 v8, s64, v3
  s_movk_i32 s64, 512
  s_branch L_kv_go
L_kv_t1:
  s_lshl_b32 s64, s65, 9
  s_add_u32 s64, s64, 11264
  v_and_b32 v3, 1, v1
  v_lshlrev_b32 v3, 3, v3
  v_lshl_add_u32 v3, v2, 4, v3
  v_add_u32 v8, s64, v3
  s_movk_i32 s64, 128
L_kv_go:
  v_add_u32 v9, s64, v8
  v_add_u32 v10, s64, v9
  v_add_u32 v11, s64, v10
  v_and_b32 v3, 31, v1
  v_mad_u32_u24 v3, v5, 24, v3
  v_lshlrev_b32 v13, 4, v3
  v_lshlrev_b32 v19, 3, v3
  s_lshl_b32 s64, s22, 3
  s_add_u32 s64, s64, s23
  s_mul_i32 s64, s64, 3840
  s_mul_i32 s65, s65, 1920
  s_add_u32 s64, s64, s65
  s_add_u32 s72, s64, 12582912
  s_barrier
  ds_read_b64_tr_b16 v[36:37], v8 offset:0
  ds_read_b64_tr_b16 v[38:39], v9 offset:0
  ds_read_b128 v[40:43], v12 offset:0
  ds_read_b64_tr_b16 v[44:45], v10 offset:0
  ds_read_b64_tr_b16 v[46:47], v11 offset:0
  ds_read_b128 v[48:51], v12 offset:672
  ds_read_b64_tr_b16 v[52:53], v8 offset:12288
  ds_read_b64_tr_b16 v[54:55], v9 offset:12288
  ds_read_b128 v[56:59], v12 offset:12288
  s_waitcnt lgkmcnt(6)
  v_mfma_f32_32x32x16_bf16 v[20:35], v[36:39], v[40:43], 0
  ds_read_b64_tr_b16 v[60:61], v10 offset:12288
  ds_read_b64_tr_b16 v[62:63], v11 offset:12288
  ds_read_b128 v[64:67], v12 offset:12960
  s_waitcnt lgkmcnt(6)
  v_mfma_f32_32x32x16_bf16 v[20:35], v[44:47], v[48:51], v[20:35]
  ds_read_b64_tr_b16 v[36:37], v8 offset:24576
  ds_read_b64_tr_b16 v[38:39], v9 offset:24576
  ds_read_b128 v[40:43], v12 offset:24576
  s_waitcnt lgkmcnt(6)
  v_mfma_f32_32x32x16_bf16 v[20:35], v[52:55], v[56:59], v[20:35]
  ds_read_b64_tr_b16 v[44:45], v10 offset:24576
  ds_read_b64_tr_b16 v[46:47], v11 offset:24576
  ds_read_b128 v[48:51], v12 offset:25248
  s_waitcnt lgkmcnt(6)
  v_mfma_f32_32x32x16_bf16 v[20:35], v[60:63], v[64:67], v[20:35]
  ds_read_b64_tr_b16 v[52:53], v8 offset:36864
  ds_read_b64_tr_b16 v[54:55], v9 offset:36864
  ds_read_b128 v[56:59], v12 offset:36864
  s_waitcnt lgkmcnt(6)
  v_mfma_f32_32x32x16_bf16 v[20:35], v[36:39], v[40:43], v[20:35]
  ds_read_b64_tr_b16 v[60:61], v10 offset:36864
  ds_read_b64_tr_b16 v[62:63], v11 offset:36864
  ds_read_b128 v[64:67], v12 offset:37536
  s_waitcnt lgkmcnt(6)
  v_mfma_f32_32x32x16_bf16 v[20:35], v[44:47], v[48:51], v[20:35]
  v_add_u32 v8, 49152, v8
  v_add_u32 v9, 49152, v9
  v_add_u32 v10, 49152, v10
  v_add_u32 v11, 49152, v11
  v_add_u32 v12, 49152, v12
  ds_read_b64_tr_b16 v[36:37], v8 offset:0
  ds_read_b64_tr_b16 v[38:39], v9 offset:0
  ds_read_b128 v[40:43], v12 offset:0
  s_waitcnt lgkmcnt(6)
  v_mfma_f32_32x32x16_bf16 v[20:35], v[52:55], v[56:59], v[20:35]
  ds_read_b64_tr_b16 v[44:45], v10 offset:0
  ds_read_b64_tr_b16 v[46:47], v11 offset:0
  ds_read_b128 v[48:51], v12 offset:672
  s_waitcnt lgkmcnt(6)
  v_mfma_f32_32x32x16_bf16 v[20:35], v[60:63], v[64:67], v[20:35]
  ds_read_b64_tr_b16 v[52:53], v8 offset:12288
  ds_read_b64_tr_b16 v[54:55], v9 offset:12288
  ds_read_b128 v[56:59], v12 offset:12288
  s_waitcnt lgkmcnt(6)
  v_mfma_f32_32x32x16_bf16 v[20:35], v[36:39], v[40:43], v[20:35]
  ds_read_b64_tr_b16 v[60:61], v10 offset:12288
  ds_read_b64_tr_b16 v[62:63], v11 offset:12288
  ds_read_b128 v[64:67], v12 offset:12960
  s_waitcnt lgkmcnt(6)
  v_mfma_f32_32x32x16_bf16 v[20:35], v[44:47], v[48:51], v[20:35]
  ds_read_b64_tr_b16 v[36:37], v8 offset:24576
  ds_read_b64_tr_b16 v[38:39], v9 offset:24576
  ds_read_b128 v[40:43], v12 offset:24576
  s_waitcnt lgkmcnt(6)
  v_mfma_f32_32x32x16_bf16 v[20:35], v[52:55], v[56:59], v[20:35]
  ds_read_b64_tr_b16 v[44:45], v10 offset:24576
  ds_read_b64_tr_b16 v[46:47], v11 offset:24576
  ds_read_b128 v[48:51], v12 offset:25248
  s_waitcnt lgkmcnt(6)
  v_mfma_f32_32x32x16_bf16 v[20:35], v[60:63], v[64:67], v[20:35]
  ds_read_b64_tr_b16 v[52:53], v8 offset:36864
  ds_read_b64_tr_b16 v[54:55], v9 offset:36864
  ds_read_b128 v[56:59], v12 offset:36864
  s_waitcnt lgkmcnt(6)
  v_mfma_f32_32x32x16_bf16 v[20:35], v[36:39], v[40:43], v[20:35]
  ds_read_b64_tr_b16 v[60:61], v10 offset:36864
  ds_read_b64_tr_b16 v[62:63], v11 offset:36864
  ds_read_b128 v[64:67], v12 offset:37536
  s_waitcnt lgkmcnt(6)
  v_mfma_f32_32x32x16_bf16 v[20:35], v[44:47], v[48:51], v[20:35]
  s_waitcnt lgkmcnt(3)
  v_mfma_f32_32x32x16_bf16 v[20:35], v[52:55], v[56:59], v[20:35]
  s_waitcnt lgkmcnt(0)
  v_mfma_f32_32x32x16_bf16 v[20:35], v[60:63], v[64:67], v[20:35]
  s_barrier
  s_nop 10
  v_cvt_pk_bf16_f32 v36, v20, v21
  v_cvt_pk_bf16_f32 v37, v22, v23
  v_cvt_pk_bf16_f32 v38, v24, v25
  v_cvt_pk_bf16_f32 v39, v26, v27
  v_cvt_pk_bf16_f32 v40, v28, v29
  v_cvt_pk_bf16_f32 v41, v30, v31
  v_cvt_pk_bf16_f32 v42, v32, v33
  v_cvt_pk_bf16_f32 v43, v34, v35
  s_mov_b32 exec_lo, 0xffffff
  s_mov_b32 exec_hi, 0xffffff
  s_cmp_eq_u32 s66, 0
  s_cbranch_scc1 L_kv_s0
  buffer_store_dwordx2 v[36:37], v19, s[12:15], s72 offen offset:1536 sc1
  s_branch L_kv_s1
L_kv_s0:
  buffer_store_dwordx4 v[36:39], v13, s[12:15], s72 offen sc1
  buffer_store_dwordx4 v[40:43], v13, s[12:15], s72 offen offset:768 sc1
L_kv_s1:
  s_mov_b64 exec, -1
  v_mov_b32 v2, 163832
  v_mov_b32 v3, 1
  v_mov_b32 v4, s100
  v_mov_b32 v5, s101
  s_mov_b64 exec, 1
  s_waitcnt vmcnt(0)
  ds_add_rtn_u32 v3, v2, v3
  s_mov_b64 exec, 0x1
  v_lshlrev_b32 v2, 3, v1
  s_waitcnt lgkmcnt(0)
  v_cmp_eq_u32 vcc, 3, v3
  s_cbranch_vccz L_arrk
  buffer_store_dwordx2 v[4:5], v2, s[12:15], s73 offen sc1
L_arrk:
  s_mov_b64 exec, -1
  s_mul_i32 s67, s22, 30720
  s_add_u32 s67, s67, 12582912
  v_add_u32 v9, 98304, v14
  s_mov_b32 s74, 0x3f80
  s_mov_b32 s75, 0x3f800000
  s_cmp_lg_u32 s20, 0
  s_cbranch_scc1 L_nopollA
  v_lshlrev_b32 v2, 7, v1
  s_and_b32 s64, s73, 0xfffff000
  s_mov_b32 s69, 1048576
  s_mov_b32 exec_lo, 0xff
  s_mov_b32 exec_hi, 0x0
L_pollA:
  buffer_load_dwordx2 v[4:5], v2, s[12:15], s64 offen sc1
  s_sub_u32 s69, s69, 1
  s_cbranch_scc1 L_pollA_out
  s_waitcnt vmcnt(0)
  v_cmp_ne_u64 vcc, s[100:101], v[4:5]
  s_nop 0
  s_and_b64 exec, exec, vcc
  s_cbranch_scc1 L_pollA
L_pollA_out:
  s_waitcnt vmcnt(0)
  s_mov_b64 exec, -1
L_nopollA:
  s_barrier
  s_cmp_eq_u32 s20, 3
  s_cselect_b32 exec_hi, 0xffff, -1
  buffer_load_dwordx4 v[20:23], v14, s[12:15], s67 offen offset:0 sc1
  buffer_load_dwordx4 v[24:27], v14, s[12:15], s67 offen offset:3840 sc1
  s_add_u32 s67, s67, 7680
  buffer_load_dwordx4 v[28:31], v14, s[12:15], s67 offen offset:0 sc1
  buffer_load_dwordx4 v[32:35], v14, s[12:15], s67 offen offset:3840 sc1
  s_add_u32 s67, s67, 7680
  buffer_load_dwordx4 v[36:39], v14, s[12:15], s67 offen offset:0 sc1
  buffer_load_dwordx4 v[40:43], v14, s[12:15], s67 offen offset:3840 sc1
  s_add_u32 s67, s67, 7680
  buffer_load_dwordx4 v[44:47], v14, s[12:15], s67 offen offset:0 sc1
  buffer_load_dwordx4 v[48:51], v14, s[12:15], s67 offen offset:3840 sc1
  s_mov_b64 exec, -1
  s_waitcnt vmcnt(7)
  v_dot2_f32_bf16 v56, v20, s74, 0
  v_dot2_f32_bf16 v57, v20, s75, 0
  v_dot2_f32_bf16 v58, v21, s74, 0
  v_dot2_f32_bf16 v59, v21, s75, 0
  v_dot2_f32_bf16 v60, v22, s74, 0
  v_dot2_f32_bf16 v61, v22, s75, 0
  v_dot2_f32_bf16 v62, v23, s74, 0
  v_dot2_f32_bf16 v63, v23, s75, 0
  s_waitcnt vmcnt(6)
  v_dot2_f32_bf16 v56, v24, s74, v56
  v_dot2_f32_bf16 v57, v24, s75, v57
  v_dot2_f32_bf16 v58, v25, s74, v58
  v_dot2_f32_bf16 v59, v25, s75, v59
  v_dot2_f32_bf16 v60, v26, s74, v60
  v_dot2_f32_bf16 v61, v26, s75, v61
  v_dot2_f32_bf16 v62, v27, s74, v62
  v_dot2_f32_bf16 v63, v27, s75, v63
  s_waitcnt vmcnt(5)
  v_dot2_f32_bf16 v56, v28, s74, v56
  v_dot2_f32_bf16 v57, v28, s75, v57
  v_dot2_f32_bf16 v58, v29, s74, v58
  v_dot2_f32_bf16 v59, v29, s75, v59
  v_dot2_f32_bf16 v60, v30, s74, v60
  v_dot2_f32_bf16 v61, v30, s75, v61
  v_dot2_f32_bf16 v62, v31, s74, v62
  v_dot2_f32_bf16 v63, v31, s75, v63
  s_waitcnt vmcnt(4)
  v_dot2_f32_bf16 v56, v32, s74, v56
  v_dot2_f32_bf16 v57, v32, s75, v57
  v_dot2_f32_bf16 v58, v33, s74, v58
  v_dot2_f32_bf16 v59, v33, s75, v59
  v_dot2_f32_bf16 v60, v34, s74, v60
  v_dot2_f32_bf16 v61, v34, s75, v61
  v_dot2_f32_bf16 v62, v35, s74, v62
  v_dot2_f32_bf16 v63, v35, s75, v63
  s_waitcnt vmcnt(3)
  v_dot2_f32_bf16 v56, v36, s74, v56
  v_dot2_f32_bf16 v57, v36, s75, v57
  v_dot2_f32_bf16 v58, v37, s74, v58
  v_dot2_f32_bf16 v59, v37, s75, v59
  v_dot2_f32_bf16 v60, v38, s74, v60
  v_dot2_f32_bf16 v61, v38, s75, v61
  v_dot2_f32_bf16 v62, v39, s74, v62
  v_dot2_f32_bf16 v63, v39, s75, v63
  s_waitcnt vmcnt(2)
  v_dot2_f32_bf16 v56, v40, s74, v56
  v_dot2_f32_bf16 v57, v40, s75, v57
  v_dot2_f32_bf16 v58, v41, s74, v58
  v_dot2_f32_bf16 v59, v41, s75, v59
  v_dot2_f32_bf16 v60, v42, s74, v60
  v_dot2_f32_bf16 v61, v42, s75, v61
  v_dot2_f32_bf16 v62, v43, s74, v62
  v_dot2_f32_bf16 v63, v43, s75, v63
  s_waitcnt vmcnt(1)
  v_dot2_f32_bf16 v56, v44, s74, v56
  v_dot2_f32_bf16 v57, v44, s75, v57
  v_dot2_f32_bf16 v58, v45, s74, v58
  v_dot2_f32_bf16 v59, v45, s75, v59
  v_dot2_f32_bf16 v60, v46, s74, v60
  v_dot2_f32_bf16 v61, v46, s75, v61
  v_dot2_f32_bf16 v62, v47, s74, v62
  v_dot2_f32_bf16 v63, v47, s75, v63
  s_waitcnt vmcnt(0)
  v_dot2_f32_bf16 v56, v48, s74, v56
  v_dot2_f32_bf16 v57, v48, s75, v57
  v_dot2_f32_bf16 v58, v49, s74, v58
  v_dot2_f32_bf16 v59, v49, s75, v59
  v_dot2_f32_bf16 v60, v50, s74, v60
  v_dot2_f32_bf16 v61, v50, s75, v61
  v_dot2_f32_bf16 v62, v51, s74, v62
  v_dot2_f32_bf16 v63, v51, s75, v63
  v_cvt_pk_bf16_f32 v20, v56, v57
  v_cvt_pk_bf16_f32 v21, v58, v59
  v_cvt_pk_bf16_f32 v22, v60, v61
  v_cvt_pk_bf16_f32 v23, v62, v63
  ds_write_b128 v9, v[20:23]
  s_waitcnt lgkmcnt(0)
  s_barrier
  s_barrier
  s_add_u32 m0, s30, 0
  s_add_u32 s24, s71, 0
  buffer_load_dwordx4 v14, s[12:15], s24 offen sc1 lds
  s_add_u32 m0, s30, 36864
  s_add_u32 s24, s71, 36864
  buffer_load_dwordx4 v14, s[12:15], s24 offen sc1 lds
  s_add_u32 m0, s30, 40960
  s_add_u32 s24, s71, 40960
  buffer_load_dwordx4 v14, s[12:15], s24 offen sc1 lds
  s_add_u32 m0, s30, 45056
  s_add_u32 s24, s71, 45056
  buffer_load_dwordx4 v14, s[12:15], s24 offen sc1 lds
  s_add_u32 s24, s30, 49152
  s_sub_u32 m0, s31, 2048
  s_cmp_lt_u32 s20, 2
  s_cselect_b32 m0, s24, m0
  s_add_u32 s24, s71, 49152
  buffer_load_dwordx4 v14, s[12:15], s24 offen sc1 lds
  s_add_u32 m0, s31, 2048
  s_add_u32 s24, s71, 53248
  buffer_load_dwordx4 v14, s[12:15], s24 offen sc1 lds
  s_add_u32 m0, s31, 6144
  s_add_u32 s24, s71, 57344
  buffer_load_dwordx4 v14, s[12:15], s24 offen sc1 lds
  s_add_u32 m0, s31, 10240
  s_add_u32 s24, s71, 61440
  buffer_load_dwordx4 v14, s[12:15], s24 offen sc1 lds
  s_add_u32 m0, s31, 14336
  s_add_u32 s24, s71, 65536
  buffer_load_dwordx4 v14, s[12:15], s24 offen sc1 lds
  s_add_u32 m0, s31, 18432
  s_add_u32 s24, s71, 69632
  buffer_load_dwordx4 v14, s[12:15], s24 offen sc1 lds
  s_add_u32 m0, s31, 22528
  s_add_u32 s24, s71, 73728
  buffer_load_dwordx4 v14, s[12:15], s24 offen sc1 lds
  s_add_u32 m0, s31, 26624
  s_add_u32 s24, s71, 77824
  buffer_load_dwordx4 v14, s[12:15], s24 offen sc1 lds
  s_add_u32 m0, s31, 30720
  s_add_u32 s24, s71, 81920
  buffer_load_dwordx4 v14, s[12:15], s24 offen sc1 lds
  s_add_u32 m0, s31, 34816
  s_add_u32 s24, s71, 86016
  buffer_load_dwordx4 v14, s[12:15], s24 offen sc1 lds
  s_add_u32 m0, s31, 38912
  s_add_u32 s24, s71, 90112
  buffer_load_dwordx4 v14, s[12:15], s24 offen sc1 lds
  s_add_u32 m0, s31, 43008
  s_add_u32 s24, s71, 94208
  buffer_load_dwordx4 v14, s[12:15], s24 offen sc1 lds
  s_add_u32 m0, s31, 47104
  s_add_u32 s24, s71, 98304
  buffer_load_dwordx4 v14, s[12:15], s24 offen sc1 lds
L_ltail:
  v_lshlrev_b32 v2, 7, v1
  v_add_u32 v8, 51200, v14
  v_add_u32 v9, s30, v16
  s_lshr_b32 s66, s96, 2
  s_lshl_b32 s66, s66, 12
  s_add_u32 s66, s66, 14811136
  s_waitcnt vmcnt(0)
  s_cmp_lg_u32 s20, 0
  s_cbranch_scc1 L_r0
  s_mov_b32 s69, 1048576
  s_mov_b32 exec_lo, 0xffff
  s_mov_b32 exec_hi, 0x0
L_ofA:
  buffer_load_dwordx2 v[4:5], v2, s[12:15], s66 offen sc1
  s_sub_u32 s69, s69, 1
  s_cbranch_scc1 L_ofA_out
  s_waitcnt vmcnt(0)
  v_cmp_ne_u64 vcc, s[100:101], v[4:5]
  s_nop 0
  s_and_b64 exec, exec, vcc
  s_cbranch_scc1 L_ofA
L_ofA_out:
  s_waitcnt vmcnt(0)
  s_mov_b64 exec, -1
  v_mov_b32 v4, 163836
  v_mov_b32 v5, 1
  s_mov_b64 exec, 1
  ds_add_u32 v4, v5
  s_mov_b64 exec, -1
L_r0:
  s_barrier
  ds_write_b128 v8, v[68:71] offset:0
  ds_write_b128 v8, v[72:75] offset:4096
  ds_write_b128 v8, v[76:79] offset:8192
  ds_write_b128 v8, v[80:83] offset:12288
  ds_write_b128 v8, v[84:87] offset:16384
  ds_write_b128 v8, v[88:91] offset:20480
  ds_write_b128 v8, v[92:95] offset:24576
  ds_write_b128 v8, v[96:99] offset:28672
  ds_write_b128 v8, v[100:103] offset:32768
  ds_write_b128 v8, v[104:107] offset:36864
  ds_write_b128 v8, v[108:111] offset:40960
  ds_write_b128 v8, v[112:115] offset:45056
  s_cmp_ge_u32 s20, 2
  s_cbranch_scc1 L_w37a
  ds_write_b128 v8, v[116:119] offset:49152
L_w37a:
  s_cmp_lg_u32 s20, 0
  s_cbranch_scc1 L_r1
  s_add_u32 s66, s66, 32768
  s_mov_b32 s69, 1048576
  s_mov_b32 exec_lo, 0xffff
  s_mov_b32 exec_hi, 0x0
L_ofB:
  buffer_load_dwordx2 v[4:5], v2, s[12:15], s66 offen sc1
  s_sub_u32 s69, s69, 1
  s_cbranch_scc1 L_ofB_out
  s_waitcnt vmcnt(0)
  v_cmp_ne_u64 vcc, s[100:101], v[4:5]
  s_nop 0
  s_and_b64 exec, exec, vcc
  s_cbranch_scc1 L_ofB
L_ofB_out:
  s_waitcnt vmcnt(0)
  s_mov_b64 exec, -1
L_r1:
  s_waitcnt lgkmcnt(0)
  s_barrier
  s_cmp_lt_u32 s20, 2
  s_cbranch_scc1 L_w37b
  v_subrev_u32 v8, 2048, v9
  ds_write_b128 v8, v[116:119]
L_w37b:
  ds_write_b128 v9, v[120:123] offset:2048
  ds_write_b128 v9, v[124:127] offset:6144
  ds_write_b128 v9, v[128:131] offset:10240
  ds_write_b128 v9, v[132:135] offset:14336
  ds_write_b128 v9, v[136:139] offset:18432
  ds_write_b128 v9, v[140:143] offset:22528
  ds_write_b128 v9, v[144:147] offset:26624
  ds_write_b128 v9, v[148:151] offset:30720
  ds_write_b128 v9, v[152:155] offset:34816
  ds_write_b128 v9, v[156:159] offset:38912
  ds_write_b128 v9, v[160:163] offset:43008
  ds_write_b128 v9, v[164:167] offset:47104
  s_waitcnt lgkmcnt(0)
  s_barrier
  s_branch L_end
L_compute:
  s_load_dwordx4 s[52:55], s[0:1], 64
  s_load_dwordx2 s[56:57], s[0:1], 80
  s_and_b32 s24, s2, 7
  s_lshr_b32 s25, s2, 3
  s_and_b32 s23, s24, 1
  s_lshl_b32 s23, s23, 2
  s_and_b32 s26, s25, 3
  s_add_u32 s23, s23, s26
  s_lshr_b32 s21, s25, 4
  s_lshr_b32 s22, s24, 1
  s_lshl_b32 s22, s22, 2
  s_bfe_u32 s26, s25, 0x20002
  s_add_u32 s22, s22, s26
  s_sub_u32 s59, s20, 4
  s_sub_u32 s24, 11, s59
  s_cmp_lt_u32 s59, 4
  s_cselect_b32 s20, s59, s24
  s_lshr_b32 s24, s22, 2
  s_xor_b32 s24, s24, s22
  s_and_b32 s58, s24, 1
  s_lshr_b32 s25, s22, 1
  s_lshl_b32 s26, s21, 3
  s_add_u32 s26, s26, s25
  s_lshl_b32 s26, s26, 4
  v_lshrrev_b32 v2, 1, v1
  v_add_u32 v2, s26, v2
  v_mul_u32_u24 v2, 1280, v2
  v_and_b32 v3, 1, v1
  v_lshl_add_u32 v158, v3, 7, v2
  s_and_b32 s25, s25, 1
  s_lshl_b32 s26, s23, 1
  s_add_u32 s26, s26, s25
  s_lshl_b32 s26, s26, 2
  v_mul_u32_u24 v3, 57, v1
  v_lshrrev_b32 v3, 9, v3
  v_mul_u32_u24 v4, 9, v3
  v_sub_u32 v4, v1, v4
  v_add_u32 v3, s26, v3
  v_mul_u32_u24 v3, 3840, v3
  v_mul_u32_u24 v5, 11, v4
  v_lshrrev_b32 v5, 5, v5
  v_mul_u32_u24 v5, 896, v5
  v_lshl_add_u32 v4, v4, 7, v5
  v_add_u32 v3, v3, v4
  s_lshr_b32 s26, s22, 2
  s_mul_i32 s26, s26, 320
  s_and_b32 s26, s26, 0xffffff80
  v_add_u32 v159, s26, v3
  s_waitcnt lgkmcnt(0)
  s_mul_i32 s24, s23, 327680
  s_add_u32 s4, s36, s24
  s_addc_u32 s5, s37, 0
  s_mov_b32 s6, 327680
  s_mov_b32 s7, 0x20000
  s_cmp_eq_u32 s21, 0
  s_cselect_b32 s8, s46, s38
  s_cselect_b32 s9, s47, s39
  s_mov_b32 s10, 2457600
  s_mov_b32 s11, 0x20000
  s_mov_b32 s16, s50
  s_mov_b32 s17, s51
  s_mov_b32 s18, 1280
  s_mov_b32 s19, 0x20000
  s_mov_b32 s12, s56
  s_mov_b32 s13, s57
  s_mov_b32 s14, 0x10000000
  s_mov_b32 s15, 0x20000
  s_xor_b32 s76, s21, 1
  s_lshl_b32 s76, s76, 4
  s_add_u32 s76, s76, s22
  s_lshl_b32 s64, s76, 12
  s_cmp_eq_u32 s21, 0
  s_cselect_b32 s65, 9, 7
  s_lshl_b32 s65, s23, s65
  s_add_u32 s64, s64, s65
  s_add_u32 s73, s64, 14680064
  s_lshr_b32 s64, s76, 4
  s_lshl_b32 s64, s64, 3
  s_add_u32 s64, s64, s23
  s_lshl_b32 s64, s64, 5
  s_add_u32 s64, s64, s22
  s_lshl_b32 s64, s64, 7
  s_add_u32 s3, s64, 14811136
  s_and_b32 s96, s2, 7
  s_lshl_b32 s96, s96, 2
  s_lshr_b32 s24, s2, 6
  s_add_u32 s96, s96, s24
  s_bfe_u32 s97, s2, 0x30003
  s_mov_b32 s60, s54
  s_mov_b32 s61, s55
  s_mov_b32 s62, 256
  s_mov_b32 s63, 0x20000
  s_cmp_lg_u32 s59, 7
  s_cbranch_scc1 L_no7
  v_mov_b32 v2, 163824
  v_mov_b32 v4, 0
  v_mov_b32 v5, 0
  ds_write_b64 v2, v[4:5]
  ds_write_b64 v2, v[4:5] offset:8
  s_cmp_lg_u32 s2, 0
  s_cbranch_scc1 L_noep
  s_mov_b32 s64, 15204352
  buffer_load_dwordx2 v[160:161], v4, s[12:15], s64 offen sc1
L_noep:
  s_waitcnt lgkmcnt(0)
L_no7:
  v_and_b32 v2, 15, v1
  v_bfe_u32 v3, v1, 4, 1
  v_mul_u32_u24 v3, 336, v3
  v_lshrrev_b32 v4, 5, v1
  v_lshl_add_u32 v3, v4, 3, v3
  s_mul_i32 s64, s20, 5248
  s_add_u32 s64, s64, 121600
  s_mul_i32 s65, s20, 12288
  s_add_u32 s65, s65, 4096
  s_cmp_eq_u32 s21, 0
  s_cselect_b32 s77, s64, s65
  v_add_u32 v3, s77, v3
  v_lshl_add_u32 v164, v2, 4, v3
  v_add_u32 v165, 1216, v164
  v_add_u32 v166, 1472, v164
  s_mov_b32 exec_lo, 0x000f000f
  s_mov_b32 exec_hi, 0x000f000f
  v_add_u32 v165, 256, v164
  s_mov_b32 exec_lo, 0x00f000f0
  s_mov_b32 exec_hi, 0x00f000f0
  v_add_u32 v165, 1536, v164
  s_mov_b32 exec_lo, 0x01000100
  s_mov_b32 exec_hi, 0x01000100
  v_add_u32 v166, 320, v3
  s_mov_b32 exec_lo, 0x02000200
  s_mov_b32 exec_hi, 0x02000200
  v_add_u32 v166, 1664, v3
  s_mov_b64 exec, -1
  v_lshrrev_b32 v2, 5, v1
  v_mul_u32_u24 v2, 336, v2
  v_and_b32 v3, 31, v1
  v_min_u32 v3, 20, v3
  v_lshl_add_u32 v18, v3, 4, v2
  s_lshl_b32 s72, s23, 3
  s_add_u32 s72, s72, s20
  s_mul_i32 s72, s72, 81920
  s_mul_i32 s24, s76, 2560
  s_add_u32 s72, s72, s24
  v_lshlrev_b32 v16, 4, v1
  v_lshlrev_b32 v17, 3, v1
  s_cmp_eq_u32 s21, 0
  s_cbranch_scc1 L_preB
  s_cmp_lg_u32 s59, 6
  s_cbranch_scc1 L_pre
  s_mul_i32 s64, s22, 1600
  s_add_u32 s16, s40, s64
  s_addc_u32 s17, s41, 0
  s_mov_b32 s18, 1600
  s_mov_b32 s19, 0x20000
  s_mov_b32 m0, 161792
  v_lshlrev_b32 v2, 4, v1
  buffer_load_dwordx4 v2, s[16:19], 0 offen lds
  s_mov_b32 exec_hi, 0xf
  buffer_load_dwordx4 v2, s[16:19], 0 offen offset:1024 lds
  s_mov_b32 exec_hi, -1
  s_branch L_pre
L_preB:
  v_and_b32 v2, 31, v1
  v_lshrrev_b32 v3, 5, v1
  v_lshlrev_b32 v3, 2, v3
  v_sub_u32 v2, v2, v3
  v_cvt_f32_i32 v2, v2
  v_mul_f32 v2, 0x71800000, v2
  s_mov_b32 s24, 0xf1800000
  v_add_f32 v132, 0, v2
  v_med3_f32 v132, v132, s24, 0
  v_add_f32 v133, 0xf1800000, v2
  v_med3_f32 v133, v133, s24, 0
  v_add_f32 v134, 0xf2000000, v2
  v_med3_f32 v134, v134, s24, 0
  v_add_f32 v135, 0xf2400000, v2
  v_med3_f32 v135, v135, s24, 0
  v_add_f32 v136, 0xf3000000, v2
  v_med3_f32 v136, v136, s24, 0
  v_add_f32 v137, 0xf3100000, v2
  v_med3_f32 v137, v137, s24, 0
  v_add_f32 v138, 0xf3200000, v2
  v_med3_f32 v138, v138, s24, 0
  v_add_f32 v139, 0xf3300000, v2
  v_med3_f32 v139, v139, s24, 0
  v_add_f32 v140, 0xf3800000, v2
  v_med3_f32 v140, v140, s24, 0
  v_add_f32 v141, 0xf3880000, v2
  v_med3_f32 v141, v141, s24, 0
  v_add_f32 v142, 0xf3900000, v2
  v_med3_f32 v142, v142, s24, 0
  v_add_f32 v143, 0xf3980000, v2
  v_med3_f32 v143, v143, s24, 0
  v_add_f32 v144, 0xf3c00000, v2
  v_med3_f32 v144, v144, s24, 0
  v_add_f32 v145, 0xf3c80000, v2
  v_med3_f32 v145, v145, s24, 0
  v_add_f32 v146, 0xf3d00000, v2
  v_med3_f32 v146, v146, s24, 0
  v_add_f32 v147, 0xf3d80000, v2
  v_med3_f32 v147, v147, s24, 0
  s_mov_b32 s74, 0x3ea52b5c
  s_mov_b32 s75, 0x3ea52b5c
  v_bfe_u32 v2, v1, 4, 1
  v_cmp_eq_u32 vcc, 0, v2
  v_mov_b32 v2, s74
  v_add_u32 v148, s77, v16
  v_add_u32 v149, s77, v17
  v_cndmask_b32 v150, 1.0, v2, vcc
  v_cndmask_b32 v151, 1.0, v2, vcc
  s_lshl_b32 s64, s20, 7
  s_add_u32 s64, s64, 96256
  v_and_b32 v152, 48, v1
  v_add_u32 v152, s64, v152
  v_and_b32 v153, 31, v1
  v_lshl_add_u32 v153, v153, 2, s64
L_pre:
  s_mul_i32 s28, s20, 12288
  v_and_b32 v2, 15, v1
  v_lshrrev_b32 v3, 4, v1
  v_bfe_u32 v4, v1, 1, 3
  v_xor_b32 v4, v3, v4
  v_lshlrev_b32 v4, 4, v4
  v_lshl_add_u32 v4, v2, 7, v4
  v_add_u32 v6, s28, v4
  v_xor_b32 v7, 64, v6
  v_bfe_u32 v2, v1, 2, 2
  v_lshl_add_u32 v3, v3, 3, v2
  v_lshlrev_b32 v3, 8, v3
  v_bfe_u32 v2, v1, 2, 3
  v_lshl_add_u32 v3, v2, 5, v3
  v_add_u32 v3, 98304, v3
  v_and_b32 v4, 1, v1
  v_bfe_u32 v5, v1, 1, 1
  v_lshl_add_u32 v4, v4, 1, v5
  v_lshl_add_u32 v8, v4, 3, v3
  v_xor_b32 v9, 32, v8
  v_xor_b32 v10, 64, v8
  v_xor_b32 v11, 96, v8
  v_xor_b32 v12, 128, v8
  v_and_b32 v4, 3, v1
  v_lshl_add_u32 v5, v4, 3, v3
  v_xor_b32 v13, 160, v5
  v_xor_b32 v14, 192, v5
  v_min_u32 v4, 3, v4
  v_lshl_add_u32 v5, v4, 3, v3
  v_xor_b32 v15, 224, v5
  s_setprio 1
  s_barrier
  ds_read_b128 v[20:23], v6 offset:0
  ds_read_b128 v[24:27], v6 offset:2048
  ds_read_b64_tr_b16 v[36:37], v8 offset:0
  ds_read_b64_tr_b16 v[38:39], v8 offset:1024
  ds_read_b64_tr_b16 v[40:41], v9 offset:0
  ds_read_b64_tr_b16 v[42:43], v9 offset:1024
  ds_read_b64_tr_b16 v[44:45], v10 offset:0
  ds_read_b64_tr_b16 v[46:47], v10 offset:1024
  ds_read_b64_tr_b16 v[48:49], v11 offset:0
  ds_read_b64_tr_b16 v[50:51], v11 offset:1024
  ds_read_b64_tr_b16 v[52:53], v12 offset:0
  ds_read_b64_tr_b16 v[54:55], v12 offset:1024
  ds_read_b64_tr_b16 v[56:57], v13 offset:0
  ds_read_b64_tr_b16 v[58:59], v13 offset:1024
  ds_read_b64_tr_b16 v[60:61], v14 offset:0
  ds_read_b64_tr_b16 v[62:63], v14 offset:1024
  ds_read_b64_tr_b16 v[64:65], v15 offset:0
  ds_read_b64_tr_b16 v[66:67], v15 offset:1024
  s_waitcnt lgkmcnt(12)
  v_mfma_f32_16x16x32_bf16 v[68:71], v[36:39], v[20:23], 0
  ds_read_b128 v[28:31], v7 offset:0
  v_mfma_f32_16x16x32_bf16 v[72:75], v[36:39], v[24:27], 0
  ds_read_b128 v[32:35], v7 offset:2048
  v_mfma_f32_16x16x32_bf16 v[76:79], v[40:43], v[20:23], 0
  ds_read_b64_tr_b16 v[36:37], v8 offset:8192
  v_mfma_f32_16x16x32_bf16 v[80:83], v[40:43], v[24:27], 0
  ds_read_b64_tr_b16 v[38:39], v8 offset:9216
  s_waitcnt lgkmcnt(12)
  v_mfma_f32_16x16x32_bf16 v[84:87], v[44:47], v[20:23], 0
  ds_read_b64_tr_b16 v[40:41], v9 offset:8192
  v_mfma_f32_16x16x32_bf16 v[88:91], v[44:47], v[24:27], 0
  ds_read_b64_tr_b16 v[42:43], v9 offset:9216
  v_mfma_f32_16x16x32_bf16 v[92:95], v[48:51], v[20:23], 0
  ds_read_b64_tr_b16 v[44:45], v10 offset:8192
  v_mfma_f32_16x16x32_bf16 v[96:99], v[48:51], v[24:27], 0
  ds_read_b64_tr_b16 v[46:47], v10 offset:9216
  s_cmp_lg_u32 s59, 2
  s_cbranch_scc1 L_t2h0
  s_bitcmp0_b32 0x566a, s22
  s_cbranch_scc1 L_t2h0
  s_mov_b32 exec_hi, 0xf
  s_mov_b32 s35, 983040
  buffer_load_dword v167, v159, s[8:11], s35 offen
  s_mov_b32 s34, 1228800
  buffer_load_dword v167, v159, s[8:11], s34 offen
  s_mov_b32 exec_lo, -1
  s_mov_b32 exec_hi, 0
  buffer_load_dword v167, v158, s[4:7], 0 offen offset:512
  s_mov_b64 exec, -1
L_t2h0:
  s_waitcnt lgkmcnt(12)
  v_mfma_f32_16x16x32_bf16 v[100:103], v[52:55], v[20:23], 0
  ds_read_b64_tr_b16 v[48:49], v11 offset:8192
  v_mfma_f32_16x16x32_bf16 v[104:107], v[52:55], v[24:27], 0
  ds_read_b64_tr_b16 v[50:51], v11 offset:9216
  v_mfma_f32_16x16x32_bf16 v[108:111], v[20:23], v[56:59], 0
  ds_read_b64_tr_b16 v[52:53], v12 offset:8192
  v_mfma_f32_16x16x32_bf16 v[112:115], v[24:27], v[56:59], 0
  ds_read_b64_tr_b16 v[54:55], v12 offset:9216
  s_cmp_lg_u32 s59, 5
  s_cbranch_scc1 L_noft
  s_and_b32 s33, s76, 30
  s_and_b32 s24, s23, 1
  s_add_u32 s33, s33, s24
  s_lshr_b32 s24, s23, 1
  s_lshl_b32 s24, s24, 5
  s_add_u32 s33, s33, s24
  s_lshl_b32 s33, s33, 7
  s_add_u32 s33, s33, 14876672
  v_lshl_add_u32 v158, v1, 7, s73
  v_writelane_b32 v158, s3, 4
  v_writelane_b32 v158, s33, 5
  s_cmp_eq_u32 s21, 0
  s_cselect_b64 exec, 63, 49
  buffer_load_dword v167, v158, s[12:15], 0 offen sc1
  s_mov_b64 exec, -1
L_noft:
  s_waitcnt lgkmcnt(12)
  v_mfma_f32_16x16x32_bf16 v[116:119], v[20:23], v[60:63], 0
  ds_read_b64_tr_b16 v[56:57], v13 offset:8192
  v_mfma_f32_16x16x32_bf16 v[120:123], v[24:27], v[60:63], 0
  ds_read_b64_tr_b16 v[58:59], v13 offset:9216
  v_mfma_f32_16x16x32_bf16 v[124:127], v[20:23], v[64:67], 0
  ds_read_b64_tr_b16 v[60:61], v14 offset:8192
  v_mfma_f32_16x16x32_bf16 v[128:131], v[24:27], v[64:67], 0
  ds_read_b64_tr_b16 v[62:63], v14 offset:9216
  s_waitcnt lgkmcnt(10)
  v_mfma_f32_16x16x32_bf16 v[68:71], v[36:39], v[28:31], v[68:71]
  ds_read_b64_tr_b16 v[64:65], v15 offset:8192
  ds_read_b64_tr_b16 v[66:67], v15 offset:9216
  v_mfma_f32_16x16x32_bf16 v[72:75], v[36:39], v[32:35], v[72:75]
  v_mfma_f32_16x16x32_bf16 v[76:79], v[40:43], v[28:31], v[76:79]
  v_mfma_f32_16x16x32_bf16 v[80:83], v[40:43], v[32:35], v[80:83]
  s_waitcnt lgkmcnt(0)
  s_barrier
  v_mfma_f32_16x16x32_bf16 v[84:87], v[44:47], v[28:31], v[84:87]
  ds_read_b128 v[20:23], v6 offset:4096
  ds_read_b128 v[24:27], v6 offset:6144
  v_mfma_f32_16x16x32_bf16 v[88:91], v[44:47], v[32:35], v[88:91]
  ds_read_b64_tr_b16 v[36:37], v8 offset:16384
  ds_read_b64_tr_b16 v[38:39], v8 offset:17408
  v_mfma_f32_16x16x32_bf16 v[92:95], v[48:51], v[28:31], v[92:95]
  ds_read_b64_tr_b16 v[40:41], v9 offset:16384
  ds_read_b64_tr_b16 v[42:43], v9 offset:17408
  v_mfma_f32_16x16x32_bf16 v[96:99], v[48:51], v[32:35], v[96:99]
  ds_read_b64_tr_b16 v[44:45], v10 offset:16384
  ds_read_b64_tr_b16 v[46:47], v10 offset:17408
  v_mfma_f32_16x16x32_bf16 v[100:103], v[52:55], v[28:31], v[100:103]
  ds_read_b64_tr_b16 v[48:49], v11 offset:16384
  v_mfma_f32_16x16x32_bf16 v[104:107], v[52:55], v[32:35], v[104:107]
  ds_read_b64_tr_b16 v[50:51], v11 offset:17408
  v_mfma_f32_16x16x32_bf16 v[108:111], v[28:31], v[56:59], v[108:111]
  ds_read_b64_tr_b16 v[52:53], v12 offset:16384
  v_mfma_f32_16x16x32_bf16 v[112:115], v[32:35], v[56:59], v[112:115]
  ds_read_b64_tr_b16 v[54:55], v12 offset:17408
  v_mfma_f32_16x16x32_bf16 v[116:119], v[28:31], v[60:63], v[116:119]
  ds_read_b64_tr_b16 v[56:57], v13 offset:16384
  v_mfma_f32_16x16x32_bf16 v[120:123], v[32:35], v[60:63], v[120:123]
  ds_read_b64_tr_b16 v[58:59], v13 offset:17408
  v_mfma_f32_16x16x32_bf16 v[124:127], v[28:31], v[64:67], v[124:127]
  ds_read_b64_tr_b16 v[60:61], v14 offset:16384
  v_mfma_f32_16x16x32_bf16 v[128:131], v[32:35], v[64:67], v[128:131]
  ds_read_b64_tr_b16 v[62:63], v14 offset:17408
  s_waitcnt lgkmcnt(10)
  v_mfma_f32_16x16x32_bf16 v[68:71], v[36:39], v[20:23], v[68:71]
  ds_read_b64_tr_b16 v[64:65], v15 offset:16384
  ds_read_b64_tr_b16 v[66:67], v15 offset:17408
  v_mfma_f32_16x16x32_bf16 v[72:75], v[36:39], v[24:27], v[72:75]
  ds_read_b128 v[28:31], v7 offset:4096
  ds_read_b128 v[32:35], v7 offset:6144
  v_mfma_f32_16x16x32_bf16 v[76:79], v[40:43], v[20:23], v[76:79]
  ds_read_b64_tr_b16 v[36:37], v8 offset:24576
  v_mfma_f32_16x16x32_bf16 v[80:83], v[40:43], v[24:27], v[80:83]
  ds_read_b64_tr_b16 v[38:39], v8 offset:25600
  s_waitcnt lgkmcnt(12)
  v_mfma_f32_16x16x32_bf16 v[84:87], v[44:47], v[20:23], v[84:87]
  ds_read_b64_tr_b16 v[40:41], v9 offset:24576
  v_mfma_f32_16x16x32_bf16 v[88:91], v[44:47], v[24:27], v[88:91]
  ds_read_b64_tr_b16 v[42:43], v9 offset:25600
  v_mfma_f32_16x16x32_bf16 v[92:95], v[48:51], v[20:23], v[92:95]
  ds_read_b64_tr_b16 v[44:45], v10 offset:24576
  v_mfma_f32_16x16x32_bf16 v[96:99], v[48:51], v[24:27], v[96:99]
  ds_read_b64_tr_b16 v[46:47], v10 offset:25600
  s_waitcnt lgkmcnt(12)
  v_mfma_f32_16x16x32_bf16 v[100:103], v[52:55], v[20:23], v[100:103]
  ds_read_b64_tr_b16 v[48:49], v11 offset:24576
  v_mfma_f32_16x16x32_bf16 v[104:107], v[52:55], v[24:27], v[104:107]
  ds_read_b64_tr_b16 v[50:51], v11 offset:25600
  v_mfma_f32_16x16x32_bf16 v[108:111], v[20:23], v[56:59], v[108:111]
  ds_read_b64_tr_b16 v[52:53], v12 offset:24576
  v_mfma_f32_16x16x32_bf16 v[112:115], v[24:27], v[56:59], v[112:115]
  ds_read_b64_tr_b16 v[54:55], v12 offset:25600
  s_xor_b32 s24, s59, 7
  s_or_b32 s24, s2, s24
  s_cmp_lg_u32 s24, 0
  s_cbranch_scc1 L_noep2
  s_mov_b32 s64, 15204352
  s_mov_b32 s65, 0x4c957f2d
  s_mov_b32 s66, 0x5851f42d
  v_mov_b32 v4, 0xf767814f
  v_mov_b32 v5, 0x14057b7e
  s_waitcnt vmcnt(0)
  v_mul_lo_u32 v162, v160, s66
  v_mul_lo_u32 v163, v161, s65
  v_mad_u64_u32 v[4:5], vcc, v160, s65, v[4:5]
  v_mov_b32 v2, 0
  v_mov_b32 v160, v4
  v_add3_u32 v161, v5, v162, v163
  v_mov_b32 v162, 1
  v_mov_b32 v163, 0
  s_mov_b64 exec, 1
  buffer_store_dwordx2 v[160:161], v2, s[12:15], s64 offen sc1
  buffer_store_dwordx4 v[160:163], v2, s[60:63], 0 offen sc1
  s_mov_b64 exec, -1
L_noep2:
  s_waitcnt lgkmcnt(12)
  v_mfma_f32_16x16x32_bf16 v[116:119], v[20:23], v[60:63], v[116:119]
  ds_read_b64_tr_b16 v[56:57], v13 offset:24576
  v_mfma_f32_16x16x32_bf16 v[120:123], v[24:27], v[60:63], v[120:123]
  ds_read_b64_tr_b16 v[58:59], v13 offset:25600
  v_mfma_f32_16x16x32_bf16 v[124:127], v[20:23], v[64:67], v[124:127]
  ds_read_b64_tr_b16 v[60:61], v14 offset:24576
  v_mfma_f32_16x16x32_bf16 v[128:131], v[24:27], v[64:67], v[128:131]
  ds_read_b64_tr_b16 v[62:63], v14 offset:25600
  s_waitcnt lgkmcnt(10)
  v_mfma_f32_16x16x32_bf16 v[68:71], v[36:39], v[28:31], v[68:71]
  ds_read_b64_tr_b16 v[64:65], v15 offset:24576
  ds_read_b64_tr_b16 v[66:67], v15 offset:25600
  v_mfma_f32_16x16x32_bf16 v[72:75], v[36:39], v[32:35], v[72:75]
  v_mfma_f32_16x16x32_bf16 v[76:79], v[40:43], v[28:31], v[76:79]
  v_mfma_f32_16x16x32_bf16 v[80:83], v[40:43], v[32:35], v[80:83]
  s_waitcnt lgkmcnt(0)
  s_barrier
  v_mfma_f32_16x16x32_bf16 v[84:87], v[44:47], v[28:31], v[84:87]
  ds_read_b128 v[20:23], v6 offset:8192
  ds_read_b128 v[24:27], v6 offset:10240
  v_mfma_f32_16x16x32_bf16 v[88:91], v[44:47], v[32:35], v[88:91]
  ds_read_b64_tr_b16 v[36:37], v8 offset:32768
  ds_read_b64_tr_b16 v[38:39], v8 offset:33792
  v_mfma_f32_16x16x32_bf16 v[92:95], v[48:51], v[28:31], v[92:95]
  ds_read_b64_tr_b16 v[40:41], v9 offset:32768
  ds_read_b64_tr_b16 v[42:43], v9 offset:33792
  v_mfma_f32_16x16x32_bf16 v[96:99], v[48:51], v[32:35], v[96:99]
  ds_read_b64_tr_b16 v[44:45], v10 offset:32768
  ds_read_b64_tr_b16 v[46:47], v10 offset:33792
  s_cmp_lg_u32 s59, 3
  s_cbranch_scc1 L_t2h3
  s_bitcmp0_b32 0xa5a5, s22
  s_cbranch_scc1 L_t2h3
  s_mov_b32 exec_hi, 0xf
  s_mov_b32 s35, 1474560
  buffer_load_dword v167, v159, s[8:11], s35 offen
  s_mov_b32 s34, 1720320
  buffer_load_dword v167, v159, s[8:11], s34 offen
  s_mov_b32 exec_lo, -1
  s_mov_b32 exec_hi, 0
  buffer_load_dword v167, v158, s[4:7], 0 offen offset:768
  s_mov_b64 exec, -1
L_t2h3:
  v_mfma_f32_16x16x32_bf16 v[100:103], v[52:55], v[28:31], v[100:103]
  ds_read_b64_tr_b16 v[48:49], v11 offset:32768
  v_mfma_f32_16x16x32_bf16 v[104:107], v[52:55], v[32:35], v[104:107]
  ds_read_b64_tr_b16 v[50:51], v11 offset:33792
  v_mfma_f32_16x16x32_bf16 v[108:111], v[28:31], v[56:59], v[108:111]
  ds_read_b64_tr_b16 v[52:53], v12 offset:32768
  v_mfma_f32_16x16x32_bf16 v[112:115], v[32:35], v[56:59], v[112:115]
  ds_read_b64_tr_b16 v[54:55], v12 offset:33792
  v_mfma_f32_16x16x32_bf16 v[116:119], v[28:31], v[60:63], v[116:119]
  ds_read_b64_tr_b16 v[56:57], v13 offset:32768
  v_mfma_f32_16x16x32_bf16 v[120:123], v[32:35], v[60:63], v[120:123]
  ds_read_b64_tr_b16 v[58:59], v13 offset:33792
  v_mfma_f32_16x16x32_bf16 v[124:127], v[28:31], v[64:67], v[124:127]
  ds_read_b64_tr_b16 v[60:61], v14 offset:32768
  v_mfma_f32_16x16x32_bf16 v[128:131], v[32:35], v[64:67], v[128:131]
  ds_read_b64_tr_b16 v[62:63], v14 offset:33792
  s_waitcnt lgkmcnt(10)
  v_mfma_f32_16x16x32_bf16 v[68:71], v[36:39], v[20:23], v[68:71]
  ds_read_b64_tr_b16 v[64:65], v15 offset:32768
  ds_read_b64_tr_b16 v[66:67], v15 offset:33792
  v_mfma_f32_16x16x32_bf16 v[72:75], v[36:39], v[24:27], v[72:75]
  ds_read_b128 v[28:31], v7 offset:8192
  ds_read_b128 v[32:35], v7 offset:10240
  v_mfma_f32_16x16x32_bf16 v[76:79], v[40:43], v[20:23], v[76:79]
  ds_read_b64_tr_b16 v[36:37], v8 offset:40960
  v_mfma_f32_16x16x32_bf16 v[80:83], v[40:43], v[24:27], v[80:83]
  ds_read_b64_tr_b16 v[38:39], v8 offset:41984
  s_waitcnt lgkmcnt(12)
  v_mfma_f32_16x16x32_bf16 v[84:87], v[44:47], v[20:23], v[84:87]
  ds_read_b64_tr_b16 v[40:41], v9 offset:40960
  v_mfma_f32_16x16x32_bf16 v[88:91], v[44:47], v[24:27], v[88:91]
  ds_read_b64_tr_b16 v[42:43], v9 offset:41984
  v_mfma_f32_16x16x32_bf16 v[92:95], v[48:51], v[20:23], v[92:95]
  ds_read_b64_tr_b16 v[44:45], v10 offset:40960
  v_mfma_f32_16x16x32_bf16 v[96:99], v[48:51], v[24:27], v[96:99]
  ds_read_b64_tr_b16 v[46:47], v10 offset:41984
  s_waitcnt lgkmcnt(12)
  v_mfma_f32_16x16x32_bf16 v[100:103], v[52:55], v[20:23], v[100:103]
  ds_read_b64_tr_b16 v[48:49], v11 offset:40960
  v_mfma_f32_16x16x32_bf16 v[104:107], v[52:55], v[24:27], v[104:107]
  ds_read_b64_tr_b16 v[50:51], v11 offset:41984
  v_mfma_f32_16x16x32_bf16 v[108:111], v[20:23], v[56:59], v[108:111]
  ds_read_b64_tr_b16 v[52:53], v12 offset:40960
  v_mfma_f32_16x16x32_bf16 v[112:115], v[24:27], v[56:59], v[112:115]
  ds_read_b64_tr_b16 v[54:55], v12 offset:41984
  s_waitcnt lgkmcnt(12)
  v_mfma_f32_16x16x32_bf16 v[116:119], v[20:23], v[60:63], v[116:119]
  ds_read_b64_tr_b16 v[56:57], v13 offset:40960
  v_mfma_f32_16x16x32_bf16 v[120:123], v[24:27], v[60:63], v[120:123]
  ds_read_b64_tr_b16 v[58:59], v13 offset:41984
  v_mfma_f32_16x16x32_bf16 v[124:127], v[20:23], v[64:67], v[124:127]
  ds_read_b64_tr_b16 v[60:61], v14 offset:40960
  v_mfma_f32_16x16x32_bf16 v[128:131], v[24:27], v[64:67], v[128:131]
  ds_read_b64_tr_b16 v[62:63], v14 offset:41984
  s_waitcnt lgkmcnt(10)
  v_mfma_f32_16x16x32_bf16 v[68:71], v[36:39], v[28:31], v[68:71]
  ds_read_b64_tr_b16 v[64:65], v15 offset:40960
  ds_read_b64_tr_b16 v[66:67], v15 offset:41984
  v_mfma_f32_16x16x32_bf16 v[72:75], v[36:39], v[32:35], v[72:75]
  v_mfma_f32_16x16x32_bf16 v[76:79], v[40:43], v[28:31], v[76:79]
  v_mfma_f32_16x16x32_bf16 v[80:83], v[40:43], v[32:35], v[80:83]
  s_waitcnt lgkmcnt(0)
  s_barrier
  v_mfma_f32_16x16x32_bf16 v[84:87], v[44:47], v[28:31], v[84:87]
  ds_read_b128 v[20:23], v6 offset:0
  ds_read_b128 v[24:27], v6 offset:2048
  v_mfma_f32_16x16x32_bf16 v[88:91], v[44:47], v[32:35], v[88:91]
  ds_read_b64_tr_b16 v[36:37], v8 offset:0
  ds_read_b64_tr_b16 v[38:39], v8 offset:1024
  v_mfma_f32_16x16x32_bf16 v[92:95], v[48:51], v[28:31], v[92:95]
  ds_read_b64_tr_b16 v[40:41], v9 offset:0
  ds_read_b64_tr_b16 v[42:43], v9 offset:1024
  v_mfma_f32_16x16x32_bf16 v[96:99], v[48:51], v[32:35], v[96:99]
  ds_read_b64_tr_b16 v[44:45], v10 offset:0
  ds_read_b64_tr_b16 v[46:47], v10 offset:1024
  v_mfma_f32_16x16x32_bf16 v[100:103], v[52:55], v[28:31], v[100:103]
  ds_read_b64_tr_b16 v[48:49], v11 offset:0
  v_mfma_f32_16x16x32_bf16 v[104:107], v[52:55], v[32:35], v[104:107]
  ds_read_b64_tr_b16 v[50:51], v11 offset:1024
  v_mfma_f32_16x16x32_bf16 v[108:111], v[28:31], v[56:59], v[108:111]
  ds_read_b64_tr_b16 v[52:53], v12 offset:0
  v_mfma_f32_16x16x32_bf16 v[112:115], v[32:35], v[56:59], v[112:115]
  ds_read_b64_tr_b16 v[54:55], v12 offset:1024
  v_mfma_f32_16x16x32_bf16 v[116:119], v[28:31], v[60:63], v[116:119]
  ds_read_b64_tr_b16 v[56:57], v13 offset:0
  v_mfma_f32_16x16x32_bf16 v[120:123], v[32:35], v[60:63], v[120:123]
  ds_read_b64_tr_b16 v[58:59], v13 offset:1024
  v_mfma_f32_16x16x32_bf16 v[124:127], v[28:31], v[64:67], v[124:127]
  ds_read_b64_tr_b16 v[60:61], v14 offset:0
  v_mfma_f32_16x16x32_bf16 v[128:131], v[32:35], v[64:67], v[128:131]
  ds_read_b64_tr_b16 v[62:63], v14 offset:1024
  s_waitcnt lgkmcnt(10)
  v_mfma_f32_16x16x32_bf16 v[68:71], v[36:39], v[20:23], v[68:71]
  ds_read_b64_tr_b16 v[64:65], v15 offset:0
  ds_read_b64_tr_b16 v[66:67], v15 offset:1024
  v_mfma_f32_16x16x32_bf16 v[72:75], v[36:39], v[24:27], v[72:75]
  ds_read_b128 v[28:31], v7 offset:0
  ds_read_b128 v[32:35], v7 offset:2048
  v_mfma_f32_16x16x32_bf16 v[76:79], v[40:43], v[20:23], v[76:79]
  ds_read_b64_tr_b16 v[36:37], v8 offset:8192
  v_mfma_f32_16x16x32_bf16 v[80:83], v[40:43], v[24:27], v[80:83]
  ds_read_b64_tr_b16 v[38:39], v8 offset:9216
  s_waitcnt lgkmcnt(12)
  v_mfma_f32_16x16x32_bf16 v[84:87], v[44:47], v[20:23], v[84:87]
  ds_read_b64_tr_b16 v[40:41], v9 offset:8192
  v_mfma_f32_16x16x32_bf16 v[88:91], v[44:47], v[24:27], v[88:91]
  ds_read_b64_tr_b16 v[42:43], v9 offset:9216
  v_mfma_f32_16x16x32_bf16 v[92:95], v[48:51], v[20:23], v[92:95]
  ds_read_b64_tr_b16 v[44:45], v10 offset:8192
  v_mfma_f32_16x16x32_bf16 v[96:99], v[48:51], v[24:27], v[96:99]
  ds_read_b64_tr_b16 v[46:47], v10 offset:9216
  s_waitcnt lgkmcnt(12)
  v_mfma_f32_16x16x32_bf16 v[100:103], v[52:55], v[20:23], v[100:103]
  ds_read_b64_tr_b16 v[48:49], v11 offset:8192
  v_mfma_f32_16x16x32_bf16 v[104:107], v[52:55], v[24:27], v[104:107]
  ds_read_b64_tr_b16 v[50:51], v11 offset:9216
  v_mfma_f32_16x16x32_bf16 v[108:111], v[20:23], v[56:59], v[108:111]
  ds_read_b64_tr_b16 v[52:53], v12 offset:8192
  v_mfma_f32_16x16x32_bf16 v[112:115], v[24:27], v[56:59], v[112:115]
  ds_read_b64_tr_b16 v[54:55], v12 offset:9216
  s_cmp_lg_u32 s59, 6
  s_cbranch_scc1 L_nov6
  s_waitcnt vmcnt(0)
L_nov6:
  s_waitcnt lgkmcnt(12)
  v_mfma_f32_16x16x32_bf16 v[116:119], v[20:23], v[60:63], v[116:119]
  ds_read_b64_tr_b16 v[56:57], v13 offset:8192
  v_mfma_f32_16x16x32_bf16 v[120:123], v[24:27], v[60:63], v[120:123]
  ds_read_b64_tr_b16 v[58:59], v13 offset:9216
  v_mfma_f32_16x16x32_bf16 v[124:127], v[20:23], v[64:67], v[124:127]
  ds_read_b64_tr_b16 v[60:61], v14 offset:8192
  v_mfma_f32_16x16x32_bf16 v[128:131], v[24:27], v[64:67], v[128:131]
  ds_read_b64_tr_b16 v[62:63], v14 offset:9216
  s_waitcnt lgkmcnt(10)
  v_mfma_f32_16x16x32_bf16 v[68:71], v[36:39], v[28:31], v[68:71]
  ds_read_b64_tr_b16 v[64:65], v15 offset:8192
  ds_read_b64_tr_b16 v[66:67], v15 offset:9216
  v_mfma_f32_16x16x32_bf16 v[72:75], v[36:39], v[32:35], v[72:75]
  v_mfma_f32_16x16x32_bf16 v[76:79], v[40:43], v[28:31], v[76:79]
  v_mfma_f32_16x16x32_bf16 v[80:83], v[40:43], v[32:35], v[80:83]
  s_cmp_lg_u32 s59, 7
  s_cbranch_scc1 L_noask
  v_mov_b32 v2, 0
  s_mov_b64 exec, 1
  buffer_load_dwordx4 v[160:163], v2, s[60:63], 0 offen sc1
  s_mov_b64 exec, -1
L_noask:
  s_waitcnt lgkmcnt(0)
  s_barrier
  v_mfma_f32_16x16x32_bf16 v[84:87], v[44:47], v[28:31], v[84:87]
  ds_read_b128 v[20:23], v6 offset:4096
  ds_read_b128 v[24:27], v6 offset:6144
  v_mfma_f32_16x16x32_bf16 v[88:91], v[44:47], v[32:35], v[88:91]
  ds_read_b64_tr_b16 v[36:37], v8 offset:16384
  ds_read_b64_tr_b16 v[38:39], v8 offset:17408
  v_mfma_f32_16x16x32_bf16 v[92:95], v[48:51], v[28:31], v[92:95]
  ds_read_b64_tr_b16 v[40:41], v9 offset:16384
  ds_read_b64_tr_b16 v[42:43], v9 offset:17408
  v_mfma_f32_16x16x32_bf16 v[96:99], v[48:51], v[32:35], v[96:99]
  ds_read_b64_tr_b16 v[44:45], v10 offset:16384
  ds_read_b64_tr_b16 v[46:47], v10 offset:17408
  s_cmp_lg_u32 s59, 4
  s_cbranch_scc1 L_t2h7
  s_bitcmp0_b32 0xa5a5, s22
  s_cbranch_scc1 L_t2h7
  s_mov_b32 exec_hi, 0xf
  s_mov_b32 s35, 1966080
  buffer_load_dword v167, v159, s[8:11], s35 offen
  s_mov_b32 s34, 2211840
  buffer_load_dword v167, v159, s[8:11], s34 offen
  s_mov_b32 exec_lo, -1
  s_mov_b32 exec_hi, 0
  buffer_load_dword v167, v158, s[4:7], 0 offen offset:1024
  s_mov_b64 exec, -1
L_t2h7:
  v_mfma_f32_16x16x32_bf16 v[100:103], v[52:55], v[28:31], v[100:103]
  ds_read_b64_tr_b16 v[48:49], v11 offset:16384
  v_mfma_f32_16x16x32_bf16 v[104:107], v[52:55], v[32:35], v[104:107]
  ds_read_b64_tr_b16 v[50:51], v11 offset:17408
  v_mfma_f32_16x16x32_bf16 v[108:111], v[28:31], v[56:59], v[108:111]
  ds_read_b64_tr_b16 v[52:53], v12 offset:16384
  v_mfma_f32_16x16x32_bf16 v[112:115], v[32:35], v[56:59], v[112:115]
  ds_read_b64_tr_b16 v[54:55], v12 offset:17408
  v_mfma_f32_16x16x32_bf16 v[116:119], v[28:31], v[60:63], v[116:119]
  ds_read_b64_tr_b16 v[56:57], v13 offset:16384
  v_mfma_f32_16x16x32_bf16 v[120:123], v[32:35], v[60:63], v[120:123]
  ds_read_b64_tr_b16 v[58:59], v13 offset:17408
  v_mfma_f32_16x16x32_bf16 v[124:127], v[28:31], v[64:67], v[124:127]
  ds_read_b64_tr_b16 v[60:61], v14 offset:16384
  v_mfma_f32_16x16x32_bf16 v[128:131], v[32:35], v[64:67], v[128:131]
  ds_read_b64_tr_b16 v[62:63], v14 offset:17408
  s_waitcnt lgkmcnt(10)
  v_mfma_f32_16x16x32_bf16 v[68:71], v[36:39], v[20:23], v[68:71]
  ds_read_b64_tr_b16 v[64:65], v15 offset:16384
  ds_read_b64_tr_b16 v[66:67], v15 offset:17408
  v_mfma_f32_16x16x32_bf16 v[72:75], v[36:39], v[24:27], v[72:75]
  ds_read_b128 v[28:31], v7 offset:4096
  ds_read_b128 v[32:35], v7 offset:6144
  v_mfma_f32_16x16x32_bf16 v[76:79], v[40:43], v[20:23], v[76:79]
  ds_read_b64_tr_b16 v[36:37], v8 offset:24576
  v_mfma_f32_16x16x32_bf16 v[80:83], v[40:43], v[24:27], v[80:83]
  ds_read_b64_tr_b16 v[38:39], v8 offset:25600
  s_waitcnt lgkmcnt(12)
  v_mfma_f32_16x16x32_bf16 v[84:87], v[44:47], v[20:23], v[84:87]
  ds_read_b64_tr_b16 v[40:41], v9 offset:24576
  v_mfma_f32_16x16x32_bf16 v[88:91], v[44:47], v[24:27], v[88:91]
  ds_read_b64_tr_b16 v[42:43], v9 offset:25600
  v_mfma_f32_16x16x32_bf16 v[92:95], v[48:51], v[20:23], v[92:95]
  ds_read_b64_tr_b16 v[44:45], v10 offset:24576
  v_mfma_f32_16x16x32_bf16 v[96:99], v[48:51], v[24:27], v[96:99]
  ds_read_b64_tr_b16 v[46:47], v10 offset:25600
  s_waitcnt lgkmcnt(12)
  v_mfma_f32_16x16x32_bf16 v[100:103], v[52:55], v[20:23], v[100:103]
  ds_read_b64_tr_b16 v[48:49], v11 offset:24576
  v_mfma_f32_16x16x32_bf16 v[104:107], v[52:55], v[24:27], v[104:107]
  ds_read_b64_tr_b16 v[50:51], v11 offset:25600
  v_mfma_f32_16x16x32_bf16 v[108:111], v[20:23], v[56:59], v[108:111]
  ds_read_b64_tr_b16 v[52:53], v12 offset:24576
  v_mfma_f32_16x16x32_bf16 v[112:115], v[24:27], v[56:59], v[112:115]
  ds_read_b64_tr_b16 v[54:55], v12 offset:25600
  s_waitcnt lgkmcnt(12)
  v_mfma_f32_16x16x32_bf16 v[116:119], v[20:23], v[60:63], v[116:119]
  ds_read_b64_tr_b16 v[56:57], v13 offset:24576
  v_mfma_f32_16x16x32_bf16 v[120:123], v[24:27], v[60:63], v[120:123]
  ds_read_b64_tr_b16 v[58:59], v13 offset:25600
  v_mfma_f32_16x16x32_bf16 v[124:127], v[20:23], v[64:67], v[124:127]
  ds_read_b64_tr_b16 v[60:61], v14 offset:24576
  v_mfma_f32_16x16x32_bf16 v[128:131], v[24:27], v[64:67], v[128:131]
  ds_read_b64_tr_b16 v[62:63], v14 offset:25600
  s_waitcnt lgkmcnt(10)
  v_mfma_f32_16x16x32_bf16 v[68:71], v[36:39], v[28:31], v[68:71]
  ds_read_b64_tr_b16 v[64:65], v15 offset:24576
  ds_read_b64_tr_b16 v[66:67], v15 offset:25600
  v_mfma_f32_16x16x32_bf16 v[72:75], v[36:39], v[32:35], v[72:75]
  v_mfma_f32_16x16x32_bf16 v[76:79], v[40:43], v[28:31], v[76:79]
  v_mfma_f32_16x16x32_bf16 v[80:83], v[40:43], v[32:35], v[80:83]
  s_cmp_lg_u32 s59, 7
  s_cbranch_scc1 L_notag
  v_mov_b32 v2, 0
  s_waitcnt vmcnt(0)
  v_readfirstlane_b32 s24, v162
  s_nop 0
  s_cmp_eq_u32 s24, 1
  s_cbranch_scc1 L_tag_out
  s_mov_b32 s69, 1048576
  s_mov_b32 exec_lo, 0x1
  s_mov_b32 exec_hi, 0x0
L_tag:
  buffer_load_dwordx4 v[160:163], v2, s[60:63], 0 offen sc1
  s_sub_u32 s69, s69, 1
  s_cbranch_scc1 L_tag_out
  s_waitcnt vmcnt(0)
  v_cmp_ne_u32 vcc, 1, v162
  s_nop 0
  s_and_b64 exec, exec, vcc
  s_cbranch_scc1 L_tag
L_tag_out:
  s_waitcnt vmcnt(0)
  s_mov_b64 exec, -1
  v_readfirstlane_b32 s100, v160
  v_readfirstlane_b32 s101, v161
  v_mov_b32 v2, 163816
  s_mov_b64 exec, 1
  ds_write_b64 v2, v[160:161]
  s_mov_b64 exec, -1
L_notag:
  s_waitcnt lgkmcnt(0)
  s_barrier
  v_mfma_f32_16x16x32_bf16 v[84:87], v[44:47], v[28:31], v[84:87]
  ds_read_b128 v[20:23], v6 offset:8192
  ds_read_b128 v[24:27], v6 offset:10240
  v_mfma_f32_16x16x32_bf16 v[88:91], v[44:47], v[32:35], v[88:91]
  ds_read_b64_tr_b16 v[36:37], v8 offset:32768
  ds_read_b64_tr_b16 v[38:39], v8 offset:33792
  v_mfma_f32_16x16x32_bf16 v[92:95], v[48:51], v[28:31], v[92:95]
  ds_read_b64_tr_b16 v[40:41], v9 offset:32768
  ds_read_b64_tr_b16 v[42:43], v9 offset:33792
  v_mfma_f32_16x16x32_bf16 v[96:99], v[48:51], v[32:35], v[96:99]
  ds_read_b64_tr_b16 v[44:45], v10 offset:32768
  ds_read_b64_tr_b16 v[46:47], v10 offset:33792
  v_mfma_f32_16x16x32_bf16 v[100:103], v[52:55], v[28:31], v[100:103]
  ds_read_b64_tr_b16 v[48:49], v11 offset:32768
  v_mfma_f32_16x16x32_bf16 v[104:107], v[52:55], v[32:35], v[104:107]
  ds_read_b64_tr_b16 v[50:51], v11 offset:33792
  v_mfma_f32_16x16x32_bf16 v[108:111], v[28:31], v[56:59], v[108:111]
  ds_read_b64_tr_b16 v[52:53], v12 offset:32768
  v_mfma_f32_16x16x32_bf16 v[112:115], v[32:35], v[56:59], v[112:115]
  ds_read_b64_tr_b16 v[54:55], v12 offset:33792
  s_xor_b32 s24, s59, 7
  s_or_b32 s24, s58, s24
  s_cmp_lg_u32 s24, 0
  s_cbranch_scc1 L_nowf
  s_and_b32 s33, s76, 30
  s_and_b32 s24, s23, 1
  s_add_u32 s33, s33, s24
  s_lshr_b32 s24, s23, 1
  s_lshl_b32 s24, s24, 5
  s_add_u32 s33, s33, s24
  s_lshl_b32 s33, s33, 7
  s_add_u32 s33, s33, 14876672
  v_lshlrev_b32 v2, 3, v1
  v_mov_b32 v4, s100
  v_mov_b32 v5, s101
  s_mov_b64 exec, 0x1
  buffer_store_dwordx2 v[4:5], v2, s[12:15], s33 offen sc1
  s_mov_b64 exec, -1
L_nowf:
  v_mfma_f32_16x16x32_bf16 v[116:119], v[28:31], v[60:63], v[116:119]
  ds_read_b64_tr_b16 v[56:57], v13 offset:32768
  v_mfma_f32_16x16x32_bf16 v[120:123], v[32:35], v[60:63], v[120:123]
  ds_read_b64_tr_b16 v[58:59], v13 offset:33792
  v_mfma_f32_16x16x32_bf16 v[124:127], v[28:31], v[64:67], v[124:127]
  ds_read_b64_tr_b16 v[60:61], v14 offset:32768
  v_mfma_f32_16x16x32_bf16 v[128:131], v[32:35], v[64:67], v[128:131]
  ds_read_b64_tr_b16 v[62:63], v14 offset:33792
  s_waitcnt lgkmcnt(10)
  v_mfma_f32_16x16x32_bf16 v[68:71], v[36:39], v[20:23], v[68:71]
  ds_read_b64_tr_b16 v[64:65], v15 offset:32768
  ds_read_b64_tr_b16 v[66:67], v15 offset:33792
  v_mfma_f32_16x16x32_bf16 v[72:75], v[36:39], v[24:27], v[72:75]
  ds_read_b128 v[28:31], v7 offset:8192
  ds_read_b128 v[32:35], v7 offset:10240
  v_mfma_f32_16x16x32_bf16 v[76:79], v[40:43], v[20:23], v[76:79]
  ds_read_b64_tr_b16 v[36:37], v8 offset:40960
  v_mfma_f32_16x16x32_bf16 v[80:83], v[40:43], v[24:27], v[80:83]
  ds_read_b64_tr_b16 v[38:39], v8 offset:41984
  s_waitcnt lgkmcnt(12)
  v_mfma_f32_16x16x32_bf16 v[84:87], v[44:47], v[20:23], v[84:87]
  ds_read_b64_tr_b16 v[40:41], v9 offset:40960
  v_mfma_f32_16x16x32_bf16 v[88:91], v[44:47], v[24:27], v[88:91]
  ds_read_b64_tr_b16 v[42:43], v9 offset:41984
  v_mfma_f32_16x16x32_bf16 v[92:95], v[48:51], v[20:23], v[92:95]
  ds_read_b64_tr_b16 v[44:45], v10 offset:40960
  v_mfma_f32_16x16x32_bf16 v[96:99], v[48:51], v[24:27], v[96:99]
  ds_read_b64_tr_b16 v[46:47], v10 offset:41984
  s_waitcnt lgkmcnt(12)
  v_mfma_f32_16x16x32_bf16 v[100:103], v[52:55], v[20:23], v[100:103]
  ds_read_b64_tr_b16 v[48:49], v11 offset:40960
  v_mfma_f32_16x16x32_bf16 v[104:107], v[52:55], v[24:27], v[104:107]
  ds_read_b64_tr_b16 v[50:51], v11 offset:41984
  v_mfma_f32_16x16x32_bf16 v[108:111], v[20:23], v[56:59], v[108:111]
  ds_read_b64_tr_b16 v[52:53], v12 offset:40960
  v_mfma_f32_16x16x32_bf16 v[112:115], v[24:27], v[56:59], v[112:115]
  ds_read_b64_tr_b16 v[54:55], v12 offset:41984
  s_waitcnt lgkmcnt(12)
  v_mfma_f32_16x16x32_bf16 v[116:119], v[20:23], v[60:63], v[116:119]
  ds_read_b64_tr_b16 v[56:57], v13 offset:40960
  v_mfma_f32_16x16x32_bf16 v[120:123], v[24:27], v[60:63], v[120:123]
  ds_read_b64_tr_b16 v[58:59], v13 offset:41984
  v_mfma_f32_16x16x32_bf16 v[124:127], v[20:23], v[64:67], v[124:127]
  ds_read_b64_tr_b16 v[60:61], v14 offset:40960
  v_mfma_f32_16x16x32_bf16 v[128:131], v[24:27], v[64:67], v[128:131]
  ds_read_b64_tr_b16 v[62:63], v14 offset:41984
  s_waitcnt lgkmcnt(10)
  v_mfma_f32_16x16x32_bf16 v[68:71], v[36:39], v[28:31], v[68:71]
  ds_read_b64_tr_b16 v[64:65], v15 offset:40960
  ds_read_b64_tr_b16 v[66:67], v15 offset:41984
  v_mfma_f32_16x16x32_bf16 v[72:75], v[36:39], v[32:35], v[72:75]
  v_mfma_f32_16x16x32_bf16 v[76:79], v[40:43], v[28:31], v[76:79]
  v_mfma_f32_16x16x32_bf16 v[80:83], v[40:43], v[32:35], v[80:83]
  s_waitcnt lgkmcnt(0)
  s_barrier
  v_mfma_f32_16x16x32_bf16 v[84:87], v[44:47], v[28:31], v[84:87]
  ds_read_b128 v[20:23], v6 offset:0
  ds_read_b128 v[24:27], v6 offset:2048
  v_mfma_f32_16x16x32_bf16 v[88:91], v[44:47], v[32:35], v[88:91]
  ds_read_b64_tr_b16 v[36:37], v8 offset:0
  ds_read_b64_tr_b16 v[38:39], v8 offset:1024
  v_mfma_f32_16x16x32_bf16 v[92:95], v[48:51], v[28:31], v[92:95]
  ds_read_b64_tr_b16 v[40:41], v9 offset:0
  ds_read_b64_tr_b16 v[42:43], v9 offset:1024
  v_mfma_f32_16x16x32_bf16 v[96:99], v[48:51], v[32:35], v[96:99]
  ds_read_b64_tr_b16 v[44:45], v10 offset:0
  ds_read_b64_tr_b16 v[46:47], v10 offset:1024
  v_mfma_f32_16x16x32_bf16 v[100:103], v[52:55], v[28:31], v[100:103]
  ds_read_b64_tr_b16 v[48:49], v11 offset:0
  v_mfma_f32_16x16x32_bf16 v[104:107], v[52:55], v[32:35], v[104:107]
  ds_read_b64_tr_b16 v[50:51], v11 offset:1024
  v_mfma_f32_16x16x32_bf16 v[108:111], v[28:31], v[56:59], v[108:111]
  ds_read_b64_tr_b16 v[52:53], v12 offset:0
  v_mfma_f32_16x16x32_bf16 v[112:115], v[32:35], v[56:59], v[112:115]
  ds_read_b64_tr_b16 v[54:55], v12 offset:1024
  v_mfma_f32_16x16x32_bf16 v[116:119], v[28:31], v[60:63], v[116:119]
  ds_read_b64_tr_b16 v[56:57], v13 offset:0
  v_mfma_f32_16x16x32_bf16 v[120:123], v[32:35], v[60:63], v[120:123]
  ds_read_b64_tr_b16 v[58:59], v13 offset:1024
  v_mfma_f32_16x16x32_bf16 v[124:127], v[28:31], v[64:67], v[124:127]
  ds_read_b64_tr_b16 v[60:61], v14 offset:0
  v_mfma_f32_16x16x32_bf16 v[128:131], v[32:35], v[64:67], v[128:131]
  ds_read_b64_tr_b16 v[62:63], v14 offset:1024
  s_waitcnt lgkmcnt(10)
  v_mfma_f32_16x16x32_bf16 v[68:71], v[36:39], v[20:23], v[68:71]
  ds_read_b64_tr_b16 v[64:65], v15 offset:0
  ds_read_b64_tr_b16 v[66:67], v15 offset:1024
  v_mfma_f32_16x16x32_bf16 v[72:75], v[36:39], v[24:27], v[72:75]
  ds_read_b128 v[28:31], v7 offset:0
  ds_read_b128 v[32:35], v7 offset:2048
  v_mfma_f32_16x16x32_bf16 v[76:79], v[40:43], v[20:23], v[76:79]
  ds_read_b64_tr_b16 v[36:37], v8 offset:8192
  v_mfma_f32_16x16x32_bf16 v[80:83], v[40:43], v[24:27], v[80:83]
  ds_read_b64_tr_b16 v[38:39], v8 offset:9216
  s_waitcnt lgkmcnt(12)
  v_mfma_f32_16x16x32_bf16 v[84:87], v[44:47], v[20:23], v[84:87]
  ds_read_b64_tr_b16 v[40:41], v9 offset:8192
  v_mfma_f32_16x16x32_bf16 v[88:91], v[44:47], v[24:27], v[88:91]
  ds_read_b64_tr_b16 v[42:43], v9 offset:9216
  v_mfma_f32_16x16x32_bf16 v[92:95], v[48:51], v[20:23], v[92:95]
  ds_read_b64_tr_b16 v[44:45], v10 offset:8192
  v_mfma_f32_16x16x32_bf16 v[96:99], v[48:51], v[24:27], v[96:99]
  ds_read_b64_tr_b16 v[46:47], v10 offset:9216
  s_waitcnt lgkmcnt(12)
  v_mfma_f32_16x16x32_bf16 v[100:103], v[52:55], v[20:23], v[100:103]
  ds_read_b64_tr_b16 v[48:49], v11 offset:8192
  v_mfma_f32_16x16x32_bf16 v[104:107], v[52:55], v[24:27], v[104:107]
  ds_read_b64_tr_b16 v[50:51], v11 offset:9216
  v_mfma_f32_16x16x32_bf16 v[108:111], v[20:23], v[56:59], v[108:111]
  ds_read_b64_tr_b16 v[52:53], v12 offset:8192
  v_mfma_f32_16x16x32_bf16 v[112:115], v[24:27], v[56:59], v[112:115]
  ds_read_b64_tr_b16 v[54:55], v12 offset:9216
  s_waitcnt lgkmcnt(12)
  v_mfma_f32_16x16x32_bf16 v[116:119], v[20:23], v[60:63], v[116:119]
  ds_read_b64_tr_b16 v[56:57], v13 offset:8192
  v_mfma_f32_16x16x32_bf16 v[120:123], v[24:27], v[60:63], v[120:123]
  ds_read_b64_tr_b16 v[58:59], v13 offset:9216
  v_mfma_f32_16x16x32_bf16 v[124:127], v[20:23], v[64:67], v[124:127]
  ds_read_b64_tr_b16 v[60:61], v14 offset:8192
  v_mfma_f32_16x16x32_bf16 v[128:131], v[24:27], v[64:67], v[128:131]
  ds_read_b64_tr_b16 v[62:63], v14 offset:9216
  s_waitcnt lgkmcnt(10)
  v_mfma_f32_16x16x32_bf16 v[68:71], v[36:39], v[28:31], v[68:71]
  ds_read_b64_tr_b16 v[64:65], v15 offset:8192
  ds_read_b64_tr_b16 v[66:67], v15 offset:9216
  v_mfma_f32_16x16x32_bf16 v[72:75], v[36:39], v[32:35], v[72:75]
  v_mfma_f32_16x16x32_bf16 v[76:79], v[40:43], v[28:31], v[76:79]
  v_mfma_f32_16x16x32_bf16 v[80:83], v[40:43], v[32:35], v[80:83]
  s_cmp_lg_u32 s21, 1
  s_cbranch_scc1 L_nord
  v_lshrrev_b32 v2, 5, v1
  v_bfe_u32 v3, v1, 2, 2
  v_lshl_add_u32 v4, v2, 2, v3
  v_mul_u32_u24 v4, 40, v4
  v_add_u32 v4, 161792, v4
  v_bfe_u32 v5, v1, 4, 1
  v_bfe_u32 v3, v1, 1, 1
  v_lshl_add_u32 v5, v5, 1, v3
  v_lshl_add_u32 v5, v5, 3, v4
  s_waitcnt lgkmcnt(4)
  ds_read_b64_tr_b16 v[132:133], v5 offset:0
  ds_read_b64_tr_b16 v[140:141], v4 offset:32
  ds_read_b64_tr_b16 v[134:135], v5 offset:320
  ds_read_b64_tr_b16 v[142:143], v4 offset:352
  ds_read_b64_tr_b16 v[136:137], v5 offset:960
  ds_read_b64_tr_b16 v[144:145], v4 offset:992
  ds_read_b64_tr_b16 v[138:139], v5 offset:1280
  ds_read_b64_tr_b16 v[146:147], v4 offset:1312
  ds_read_b64_tr_b16 v[148:149], v5 offset:640
  ds_read_b64_tr_b16 v[152:153], v4 offset:672
L_nord:
  s_waitcnt lgkmcnt(0)
  s_barrier
  v_mfma_f32_16x16x32_bf16 v[84:87], v[44:47], v[28:31], v[84:87]
  ds_read_b128 v[20:23], v6 offset:4096
  ds_read_b128 v[24:27], v6 offset:6144
  v_mfma_f32_16x16x32_bf16 v[88:91], v[44:47], v[32:35], v[88:91]
  ds_read_b64_tr_b16 v[36:37], v8 offset:16384
  ds_read_b64_tr_b16 v[38:39], v8 offset:17408
  v_mfma_f32_16x16x32_bf16 v[92:95], v[48:51], v[28:31], v[92:95]
  ds_read_b64_tr_b16 v[40:41], v9 offset:16384
  ds_read_b64_tr_b16 v[42:43], v9 offset:17408
  v_mfma_f32_16x16x32_bf16 v[96:99], v[48:51], v[32:35], v[96:99]
  ds_read_b64_tr_b16 v[44:45], v10 offset:16384
  ds_read_b64_tr_b16 v[46:47], v10 offset:17408
  v_mfma_f32_16x16x32_bf16 v[100:103], v[52:55], v[28:31], v[100:103]
  ds_read_b64_tr_b16 v[48:49], v11 offset:16384
  v_mfma_f32_16x16x32_bf16 v[104:107], v[52:55], v[32:35], v[104:107]
  ds_read_b64_tr_b16 v[50:51], v11 offset:17408
  s_cmp_lg_u32 s21, 1
  s_cbranch_scc1 L_nofix
  v_bfe_i32 v3, v1, 2, 1
  v_and_b32 v3, 0x80008000, v3
  v_bfe_i32 v4, v1, 3, 1
  v_bfe_i32 v5, v1, 5, 1
  v_xor_b32 v2, v4, v5
  v_xor_b32 v132, v3, v132
  v_bitop3_b32 v140, v140, v3, v4 bitop3:0x14
  v_xor_b32 v136, v3, v136
  v_bitop3_b32 v144, v144, v3, v4 bitop3:0x28
  v_xor_b32 v133, v3, v133
  v_bitop3_b32 v141, v141, v3, v4 bitop3:0x14
  v_xor_b32 v137, v3, v137
  v_bitop3_b32 v145, v145, v3, v4 bitop3:0x28
  v_xor_b32 v134, v3, v134
  v_bitop3_b32 v142, v142, v3, v4 bitop3:0x14
  v_xor_b32 v138, v3, v138
  v_bitop3_b32 v146, v146, v3, v4 bitop3:0x28
  v_xor_b32 v135, v3, v135
  v_bitop3_b32 v143, v143, v3, v4 bitop3:0x14
  v_xor_b32 v139, v3, v139
  v_bitop3_b32 v147, v147, v3, v4 bitop3:0x28
  v_bitop3_b32 v150, v148, v3, v5 bitop3:0x28
  v_bitop3_b32 v148, v148, v3, v5 bitop3:0x14
  v_bitop3_b32 v152, v152, v3, v2 bitop3:0x14
  v_bitop3_b32 v151, v149, v3, v5 bitop3:0x28
  v_bitop3_b32 v149, v149, v3, v5 bitop3:0x14
  v_bitop3_b32 v153, v153, v3, v2 bitop3:0x14
L_nofix:
  v_mfma_f32_16x16x32_bf16 v[108:111], v[28:31], v[56:59], v[108:111]
  ds_read_b64_tr_b16 v[52:53], v12 offset:16384
  v_mfma_f32_16x16x32_bf16 v[112:115], v[32:35], v[56:59], v[112:115]
  ds_read_b64_tr_b16 v[54:55], v12 offset:17408
  v_mfma_f32_16x16x32_bf16 v[116:119], v[28:31], v[60:63], v[116:119]
  ds_read_b64_tr_b16 v[56:57], v13 offset:16384
  v_mfma_f32_16x16x32_bf16 v[120:123], v[32:35], v[60:63], v[120:123]
  ds_read_b64_tr_b16 v[58:59], v13 offset:17408
  v_mfma_f32_16x16x32_bf16 v[124:127], v[28:31], v[64:67], v[124:127]
  ds_read_b64_tr_b16 v[60:61], v14 offset:16384
  v_mfma_f32_16x16x32_bf16 v[128:131], v[32:35], v[64:67], v[128:131]
  ds_read_b64_tr_b16 v[62:63], v14 offset:17408
  s_waitcnt lgkmcnt(10)
  v_mfma_f32_16x16x32_bf16 v[68:71], v[36:39], v[20:23], v[68:71]
  ds_read_b64_tr_b16 v[64:65], v15 offset:16384
  ds_read_b64_tr_b16 v[66:67], v15 offset:17408
  v_mfma_f32_16x16x32_bf16 v[72:75], v[36:39], v[24:27], v[72:75]
  ds_read_b128 v[28:31], v7 offset:4096
  ds_read_b128 v[32:35], v7 offset:6144
  v_mfma_f32_16x16x32_bf16 v[76:79], v[40:43], v[20:23], v[76:79]
  ds_read_b64_tr_b16 v[36:37], v8 offset:24576
  v_mfma_f32_16x16x32_bf16 v[80:83], v[40:43], v[24:27], v[80:83]
  ds_read_b64_tr_b16 v[38:39], v8 offset:25600
  s_waitcnt lgkmcnt(12)
  v_mfma_f32_16x16x32_bf16 v[84:87], v[44:47], v[20:23], v[84:87]
  ds_read_b64_tr_b16 v[40:41], v9 offset:24576
  v_mfma_f32_16x16x32_bf16 v[88:91], v[44:47], v[24:27], v[88:91]
  ds_read_b64_tr_b16 v[42:43], v9 offset:25600
  v_mfma_f32_16x16x32_bf16 v[92:95], v[48:51], v[20:23], v[92:95]
  ds_read_b64_tr_b16 v[44:45], v10 offset:24576
  v_mfma_f32_16x16x32_bf16 v[96:99], v[48:51], v[24:27], v[96:99]
  ds_read_b64_tr_b16 v[46:47], v10 offset:25600
  s_waitcnt lgkmcnt(12)
  v_mfma_f32_16x16x32_bf16 v[100:103], v[52:55], v[20:23], v[100:103]
  ds_read_b64_tr_b16 v[48:49], v11 offset:24576
  v_mfma_f32_16x16x32_bf16 v[104:107], v[52:55], v[24:27], v[104:107]
  ds_read_b64_tr_b16 v[50:51], v11 offset:25600
  v_mfma_f32_16x16x32_bf16 v[108:111], v[20:23], v[56:59], v[108:111]
  ds_read_b64_tr_b16 v[52:53], v12 offset:24576
  v_mfma_f32_16x16x32_bf16 v[112:115], v[24:27], v[56:59], v[112:115]
  ds_read_b64_tr_b16 v[54:55], v12 offset:25600
  s_waitcnt lgkmcnt(12)
  v_mfma_f32_16x16x32_bf16 v[116:119], v[20:23], v[60:63], v[116:119]
  ds_read_b64_tr_b16 v[56:57], v13 offset:24576
  v_mfma_f32_16x16x32_bf16 v[120:123], v[24:27], v[60:63], v[120:123]
  ds_read_b64_tr_b16 v[58:59], v13 offset:25600
  v_mfma_f32_16x16x32_bf16 v[124:127], v[20:23], v[64:67], v[124:127]
  ds_read_b64_tr_b16 v[60:61], v14 offset:24576
  v_mfma_f32_16x16x32_bf16 v[128:131], v[24:27], v[64:67], v[128:131]
  ds_read_b64_tr_b16 v[62:63], v14 offset:25600
  s_waitcnt lgkmcnt(10)
  v_mfma_f32_16x16x32_bf16 v[68:71], v[36:39], v[28:31], v[68:71]
  ds_read_b64_tr_b16 v[64:65], v15 offset:24576
  ds_read_b64_tr_b16 v[66:67], v15 offset:25600
  v_mfma_f32_16x16x32_bf16 v[72:75], v[36:39], v[32:35], v[72:75]
  v_mfma_f32_16x16x32_bf16 v[76:79], v[40:43], v[28:31], v[76:79]
  v_mfma_f32_16x16x32_bf16 v[80:83], v[40:43], v[32:35], v[80:83]
  s_waitcnt lgkmcnt(0)
  s_barrier
  v_mfma_f32_16x16x32_bf16 v[84:87], v[44:47], v[28:31], v[84:87]
  ds_read_b128 v[20:23], v6 offset:8192
  ds_read_b128 v[24:27], v6 offset:10240
  v_mfma_f32_16x16x32_bf16 v[88:91], v[44:47], v[32:35], v[88:91]
  ds_read_b64_tr_b16 v[36:37], v8 offset:32768
  ds_read_b64_tr_b16 v[38:39], v8 offset:33792
  v_mfma_f32_16x16x32_bf16 v[92:95], v[48:51], v[28:31], v[92:95]
  ds_read_b64_tr_b16 v[40:41], v9 offset:32768
  ds_read_b64_tr_b16 v[42:43], v9 offset:33792
  v_mfma_f32_16x16x32_bf16 v[96:99], v[48:51], v[32:35], v[96:99]
  ds_read_b64_tr_b16 v[44:45], v10 offset:32768
  ds_read_b64_tr_b16 v[46:47], v10 offset:33792
  v_mfma_f32_16x16x32_bf16 v[100:103], v[52:55], v[28:31], v[100:103]
  ds_read_b64_tr_b16 v[48:49], v11 offset:32768
  v_mfma_f32_16x16x32_bf16 v[104:107], v[52:55], v[32:35], v[104:107]
  ds_read_b64_tr_b16 v[50:51], v11 offset:33792
  v_mfma_f32_16x16x32_bf16 v[108:111], v[28:31], v[56:59], v[108:111]
  ds_read_b64_tr_b16 v[52:53], v12 offset:32768
  v_mfma_f32_16x16x32_bf16 v[112:115], v[32:35], v[56:59], v[112:115]
  ds_read_b64_tr_b16 v[54:55], v12 offset:33792
  s_cmp_lg_u32 s59, 7
  s_cbranch_scc1 L_nowa
  s_lshr_b32 s33, s97, 1
  s_lshl_b32 s33, s33, 12
  s_add_u32 s33, s33, 14876672
  v_lshlrev_b32 v162, 7, v1
  s_mov_b32 exec_hi, 0
  buffer_load_dwordx2 v[160:161], v162, s[12:15], s33 offen sc1
  s_mov_b32 exec_hi, -1
L_nowa:
  v_mfma_f32_16x16x32_bf16 v[116:119], v[28:31], v[60:63], v[116:119]
  ds_read_b64_tr_b16 v[56:57], v13 offset:32768
  v_mfma_f32_16x16x32_bf16 v[120:123], v[32:35], v[60:63], v[120:123]
  ds_read_b64_tr_b16 v[58:59], v13 offset:33792
  v_mfma_f32_16x16x32_bf16 v[124:127], v[28:31], v[64:67], v[124:127]
  ds_read_b64_tr_b16 v[60:61], v14 offset:32768
  v_mfma_f32_16x16x32_bf16 v[128:131], v[32:35], v[64:67], v[128:131]
  ds_read_b64_tr_b16 v[62:63], v14 offset:33792
  s_waitcnt lgkmcnt(10)
  v_mfma_f32_16x16x32_bf16 v[68:71], v[36:39], v[20:23], v[68:71]
  ds_read_b64_tr_b16 v[64:65], v15 offset:32768
  ds_read_b64_tr_b16 v[66:67], v15 offset:33792
  v_mfma_f32_16x16x32_bf16 v[72:75], v[36:39], v[24:27], v[72:75]
  ds_read_b128 v[28:31], v7 offset:8192
  ds_read_b128 v[32:35], v7 offset:10240
  v_mfma_f32_16x16x32_bf16 v[76:79], v[40:43], v[20:23], v[76:79]
  ds_read_b64_tr_b16 v[36:37], v8 offset:40960
  v_mfma_f32_16x16x32_bf16 v[80:83], v[40:43], v[24:27], v[80:83]
  ds_read_b64_tr_b16 v[38:39], v8 offset:41984
  s_waitcnt lgkmcnt(12)
  v_mfma_f32_16x16x32_bf16 v[84:87], v[44:47], v[20:23], v[84:87]
  ds_read_b64_tr_b16 v[40:41], v9 offset:40960
  v_mfma_f32_16x16x32_bf16 v[88:91], v[44:47], v[24:27], v[88:91]
  ds_read_b64_tr_b16 v[42:43], v9 offset:41984
  v_mfma_f32_16x16x32_bf16 v[92:95], v[48:51], v[20:23], v[92:95]
  ds_read_b64_tr_b16 v[44:45], v10 offset:40960
  v_mfma_f32_16x16x32_bf16 v[96:99], v[48:51], v[24:27], v[96:99]
  ds_read_b64_tr_b16 v[46:47], v10 offset:41984
  s_waitcnt lgkmcnt(12)
  v_mfma_f32_16x16x32_bf16 v[100:103], v[52:55], v[20:23], v[100:103]
  ds_read_b64_tr_b16 v[48:49], v11 offset:40960
  v_mfma_f32_16x16x32_bf16 v[104:107], v[52:55], v[24:27], v[104:107]
  ds_read_b64_tr_b16 v[50:51], v11 offset:41984
  v_mfma_f32_16x16x32_bf16 v[108:111], v[20:23], v[56:59], v[108:111]
  ds_read_b64_tr_b16 v[52:53], v12 offset:40960
  v_mfma_f32_16x16x32_bf16 v[112:115], v[24:27], v[56:59], v[112:115]
  ds_read_b64_tr_b16 v[54:55], v12 offset:41984
  s_waitcnt lgkmcnt(12)
  v_mfma_f32_16x16x32_bf16 v[116:119], v[20:23], v[60:63], v[116:119]
  ds_read_b64_tr_b16 v[56:57], v13 offset:40960
  v_mfma_f32_16x16x32_bf16 v[120:123], v[24:27], v[60:63], v[120:123]
  ds_read_b64_tr_b16 v[58:59], v13 offset:41984
  v_mfma_f32_16x16x32_bf16 v[124:127], v[20:23], v[64:67], v[124:127]
  ds_read_b64_tr_b16 v[60:61], v14 offset:40960
  v_mfma_f32_16x16x32_bf16 v[128:131], v[24:27], v[64:67], v[128:131]
  ds_read_b64_tr_b16 v[62:63], v14 offset:41984
  s_waitcnt lgkmcnt(10)
  v_mfma_f32_16x16x32_bf16 v[68:71], v[36:39], v[28:31], v[68:71]
  ds_read_b64_tr_b16 v[64:65], v15 offset:40960
  ds_read_b64_tr_b16 v[66:67], v15 offset:41984
  v_mfma_f32_16x16x32_bf16 v[72:75], v[36:39], v[32:35], v[72:75]
  v_mfma_f32_16x16x32_bf16 v[76:79], v[40:43], v[28:31], v[76:79]
  v_mfma_f32_16x16x32_bf16 v[80:83], v[40:43], v[32:35], v[80:83]
  s_cmp_lg_u32 s59, 7
  s_cbranch_scc1 L_nowc
  v_lshlrev_b32 v162, 7, v1
  s_mov_b32 exec_hi, 0
  s_waitcnt vmcnt(0)
  v_cmp_ne_u64 vcc, s[100:101], v[160:161]
  s_cbranch_vccz L_wpk_out
  s_mov_b32 s69, 1048576
  s_mov_b32 exec_lo, 0xffffffff
  s_mov_b32 exec_hi, 0x0
L_wpk:
  buffer_load_dwordx2 v[4:5], v162, s[12:15], s33 offen sc1
  s_sub_u32 s69, s69, 1
  s_cbranch_scc1 L_wpk_out
  s_waitcnt vmcnt(0)
  v_cmp_ne_u64 vcc, s[100:101], v[4:5]
  s_nop 0
  s_and_b64 exec, exec, vcc
  s_cbranch_scc1 L_wpk
L_wpk_out:
  s_waitcnt vmcnt(0)
  s_mov_b64 exec, -1
L_nowc:
  s_waitcnt lgkmcnt(0)
  s_barrier
  v_mfma_f32_16x16x32_bf16 v[84:87], v[44:47], v[28:31], v[84:87]
  ds_read_b128 v[20:23], v6 offset:0
  ds_read_b128 v[24:27], v6 offset:2048
  v_mfma_f32_16x16x32_bf16 v[88:91], v[44:47], v[32:35], v[88:91]
  ds_read_b64_tr_b16 v[36:37], v8 offset:0
  ds_read_b64_tr_b16 v[38:39], v8 offset:1024
  v_mfma_f32_16x16x32_bf16 v[92:95], v[48:51], v[28:31], v[92:95]
  ds_read_b64_tr_b16 v[40:41], v9 offset:0
  ds_read_b64_tr_b16 v[42:43], v9 offset:1024
  v_mfma_f32_16x16x32_bf16 v[96:99], v[48:51], v[32:35], v[96:99]
  ds_read_b64_tr_b16 v[44:45], v10 offset:0
  ds_read_b64_tr_b16 v[46:47], v10 offset:1024
  v_mfma_f32_16x16x32_bf16 v[100:103], v[52:55], v[28:31], v[100:103]
  ds_read_b64_tr_b16 v[48:49], v11 offset:0
  v_mfma_f32_16x16x32_bf16 v[104:107], v[52:55], v[32:35], v[104:107]
  ds_read_b64_tr_b16 v[50:51], v11 offset:1024
  v_mfma_f32_16x16x32_bf16 v[108:111], v[28:31], v[56:59], v[108:111]
  ds_read_b64_tr_b16 v[52:53], v12 offset:0
  v_mfma_f32_16x16x32_bf16 v[112:115], v[32:35], v[56:59], v[112:115]
  ds_read_b64_tr_b16 v[54:55], v12 offset:1024
  v_mfma_f32_16x16x32_bf16 v[116:119], v[28:31], v[60:63], v[116:119]
  ds_read_b64_tr_b16 v[56:57], v13 offset:0
  v_mfma_f32_16x16x32_bf16 v[120:123], v[32:35], v[60:63], v[120:123]
  ds_read_b64_tr_b16 v[58:59], v13 offset:1024
  v_mfma_f32_16x16x32_bf16 v[124:127], v[28:31], v[64:67], v[124:127]
  ds_read_b64_tr_b16 v[60:61], v14 offset:0
  v_mfma_f32_16x16x32_bf16 v[128:131], v[32:35], v[64:67], v[128:131]
  ds_read_b64_tr_b16 v[62:63], v14 offset:1024
  s_waitcnt lgkmcnt(10)
  v_mfma_f32_16x16x32_bf16 v[68:71], v[36:39], v[20:23], v[68:71]
  ds_read_b64_tr_b16 v[64:65], v15 offset:0
  ds_read_b64_tr_b16 v[66:67], v15 offset:1024
  v_mfma_f32_16x16x32_bf16 v[72:75], v[36:39], v[24:27], v[72:75]
  ds_read_b128 v[28:31], v7 offset:0
  ds_read_b128 v[32:35], v7 offset:2048
  v_mfma_f32_16x16x32_bf16 v[76:79], v[40:43], v[20:23], v[76:79]
  ds_read_b64_tr_b16 v[36:37], v8 offset:8192
  v_mfma_f32_16x16x32_bf16 v[80:83], v[40:43], v[24:27], v[80:83]
  ds_read_b64_tr_b16 v[38:39], v8 offset:9216
  s_waitcnt lgkmcnt(12)
  v_mfma_f32_16x16x32_bf16 v[84:87], v[44:47], v[20:23], v[84:87]
  ds_read_b64_tr_b16 v[40:41], v9 offset:8192
  v_mfma_f32_16x16x32_bf16 v[88:91], v[44:47], v[24:27], v[88:91]
  ds_read_b64_tr_b16 v[42:43], v9 offset:9216
  v_mfma_f32_16x16x32_bf16 v[92:95], v[48:51], v[20:23], v[92:95]
  ds_read_b64_tr_b16 v[44:45], v10 offset:8192
  v_mfma_f32_16x16x32_bf16 v[96:99], v[48:51], v[24:27], v[96:99]
  ds_read_b64_tr_b16 v[46:47], v10 offset:9216
  s_waitcnt lgkmcnt(12)
  v_mfma_f32_16x16x32_bf16 v[100:103], v[52:55], v[20:23], v[100:103]
  ds_read_b64_tr_b16 v[48:49], v11 offset:8192
  v_mfma_f32_16x16x32_bf16 v[104:107], v[52:55], v[24:27], v[104:107]
  ds_read_b64_tr_b16 v[50:51], v11 offset:9216
  v_mfma_f32_16x16x32_bf16 v[108:111], v[20:23], v[56:59], v[108:111]
  ds_read_b64_tr_b16 v[52:53], v12 offset:8192
  v_mfma_f32_16x16x32_bf16 v[112:115], v[24:27], v[56:59], v[112:115]
  ds_read_b64_tr_b16 v[54:55], v12 offset:9216
  s_waitcnt lgkmcnt(12)
  v_mfma_f32_16x16x32_bf16 v[116:119], v[20:23], v[60:63], v[116:119]
  ds_read_b64_tr_b16 v[56:57], v13 offset:8192
  v_mfma_f32_16x16x32_bf16 v[120:123], v[24:27], v[60:63], v[120:123]
  ds_read_b64_tr_b16 v[58:59], v13 offset:9216
  v_mfma_f32_16x16x32_bf16 v[124:127], v[20:23], v[64:67], v[124:127]
  ds_read_b64_tr_b16 v[60:61], v14 offset:8192
  v_mfma_f32_16x16x32_bf16 v[128:131], v[24:27], v[64:67], v[128:131]
  ds_read_b64_tr_b16 v[62:63], v14 offset:9216
  s_waitcnt lgkmcnt(10)
  v_mfma_f32_16x16x32_bf16 v[68:71], v[36:39], v[28:31], v[68:71]
  ds_read_b64_tr_b16 v[64:65], v15 offset:8192
  v_mfma_f32_16x16x32_bf16 v[72:75], v[36:39], v[32:35], v[72:75]
  ds_read_b64_tr_b16 v[66:67], v15 offset:9216
  v_mfma_f32_16x16x32_bf16 v[76:79], v[40:43], v[28:31], v[76:79]
  v_mfma_f32_16x16x32_bf16 v[80:83], v[40:43], v[32:35], v[80:83]
  s_waitcnt lgkmcnt(8)
  v_mfma_f32_16x16x32_bf16 v[84:87], v[44:47], v[28:31], v[84:87]
  v_mfma_f32_16x16x32_bf16 v[88:91], v[44:47], v[32:35], v[88:91]
  v_mfma_f32_16x16x32_bf16 v[92:95], v[48:51], v[28:31], v[92:95]
  v_mfma_f32_16x16x32_bf16 v[96:99], v[48:51], v[32:35], v[96:99]
  s_waitcnt lgkmcnt(4)
  v_mfma_f32_16x16x32_bf16 v[100:103], v[52:55], v[28:31], v[100:103]
  v_mfma_f32_16x16x32_bf16 v[104:107], v[52:55], v[32:35], v[104:107]
  v_mfma_f32_16x16x32_bf16 v[108:111], v[28:31], v[56:59], v[108:111]
  v_mfma_f32_16x16x32_bf16 v[112:115], v[32:35], v[56:59], v[112:115]
  s_waitcnt lgkmcnt(0)
  v_mfma_f32_16x16x32_bf16 v[116:119], v[28:31], v[60:63], v[116:119]
  v_mfma_f32_16x16x32_bf16 v[120:123], v[32:35], v[60:63], v[120:123]
  v_mfma_f32_16x16x32_bf16 v[124:127], v[28:31], v[64:67], v[124:127]
  v_mfma_f32_16x16x32_bf16 v[128:131], v[32:35], v[64:67], v[128:131]
  s_setprio 0
  s_cmp_eq_u32 s21, 0
  s_cbranch_scc0 L_compA
  v_pk_mul_f32 v[84:85], v[84:85], v[150:151]
  v_pk_mul_f32 v[86:87], v[86:87], v[150:151]
  v_pk_mul_f32 v[88:89], v[88:89], v[150:151]
  v_pk_mul_f32 v[90:91], v[90:91], v[150:151]
  v_cvt_pk_bf16_f32 v28, v84, v85
  v_cvt_pk_bf16_f32 v30, v88, v89
  v_cvt_pk_bf16_f32 v29, v86, v87
  v_cvt_pk_bf16_f32 v31, v90, v91
  v_cvt_pk_bf16_f32 v32, v92, v93
  v_cvt_pk_bf16_f32 v34, v96, v97
  v_cvt_pk_bf16_f32 v33, v94, v95
  v_cvt_pk_bf16_f32 v35, v98, v99
  v_permlane16_swap_b32 v28, v30
  v_permlane16_swap_b32 v29, v31
  v_cvt_pk_bf16_f32 v36, v100, v101
  v_cvt_pk_bf16_f32 v38, v104, v105
  v_cvt_pk_bf16_f32 v37, v102, v103
  v_cvt_pk_bf16_f32 v39, v106, v107
  v_permlane16_swap_b32 v32, v34
  v_permlane16_swap_b32 v33, v35
  v_cvt_pk_bf16_f32 v40, v108, v109
  v_cvt_pk_bf16_f32 v41, v110, v111
  v_cvt_pk_bf16_f32 v42, v112, v113
  v_cvt_pk_bf16_f32 v43, v114, v115
  v_permlane16_swap_b32 v36, v38
  v_permlane16_swap_b32 v37, v39
  ds_write_b64 v164, v[40:41] offset:2560
  ds_write_b64 v164, v[42:43] offset:3232
  ds_write_b128 v148, v[30:33]
  ds_write_b64 v149, v[34:35] offset:2048
  v_cvt_pk_bf16_f32 v44, v116, v117
  v_cvt_pk_bf16_f32 v45, v118, v119
  v_cvt_pk_bf16_f32 v46, v120, v121
  v_cvt_pk_bf16_f32 v47, v122, v123
  ds_write_b128 v148, v[36:39] offset:1024
  ds_write_b64 v165, v[44:45] offset:2560
  ds_write_b64 v165, v[46:47] offset:3232
  v_cvt_pk_bf16_f32 v48, v124, v125
  v_cvt_pk_bf16_f32 v49, v126, v127
  v_cvt_pk_bf16_f32 v50, v128, v129
  v_cvt_pk_bf16_f32 v51, v130, v131
  s_mov_b32 exec_lo, 0x03000300
  s_mov_b32 exec_hi, 0x03000300
  v_mov_b32 v48, 0x3f803f80
  v_mov_b32 v49, 0x3f803f80
  v_mov_b32 v50, 0x3f803f80
  v_mov_b32 v51, 0x3f803f80
  s_mov_b32 exec_lo, 0x03ff03ff
  s_mov_b32 exec_hi, 0x03ff03ff
  ds_write_b64 v166, v[48:49] offset:2560
  ds_write_b64 v166, v[50:51] offset:3232
  s_mov_b64 exec, -1
  v_pk_mul_f32 v[76:77], v[76:77], s[74:75]
  v_pk_mul_f32 v[78:79], v[78:79], s[74:75]
  v_pk_mul_f32 v[80:81], v[80:81], s[74:75]
  v_pk_mul_f32 v[82:83], v[82:83], s[74:75]
  v_cvt_pk_bf16_f32 v24, v76, v77
  v_cvt_pk_bf16_f32 v26, v80, v81
  v_cvt_pk_bf16_f32 v25, v78, v79
  v_cvt_pk_bf16_f32 v27, v82, v83
  s_waitcnt lgkmcnt(0)
  s_barrier
  v_mov_b64 v[154:155], v[124:125]
  v_mov_b64 v[156:157], v[126:127]
  v_mov_b64 v[158:159], v[128:129]
  v_mov_b64 v[160:161], v[130:131]
  v_permlane16_swap_b32 v24, v26
  v_permlane16_swap_b32 v25, v27
  v_pk_mul_f32 v[68:69], v[68:69], s[74:75]
  v_pk_mul_f32 v[70:71], v[70:71], s[74:75]
  v_pk_mul_f32 v[72:73], v[72:73], s[74:75]
  v_pk_mul_f32 v[74:75], v[74:75], s[74:75]
  v_cvt_pk_bf16_f32 v20, v68, v69
  v_cvt_pk_bf16_f32 v22, v72, v73
  v_cvt_pk_bf16_f32 v21, v70, v71
  v_cvt_pk_bf16_f32 v23, v74, v75
  v_mov_b32 v54, 0
  v_mov_b32 v55, 0
  v_permlane16_swap_b32 v20, v22
  v_permlane16_swap_b32 v21, v23
  s_mov_b32 exec_lo, 0
  v_swap_b32 v24, v54
  v_swap_b32 v25, v55
  s_mov_b32 exec_lo, -1
  s_mov_b32 s68, s20
  s_mov_b32 s65, 121600
  s_sub_u32 s67, s77, 41984
  s_mov_b32 s70, 0
  v_add_u32 v9, s77, v16
  v_add_u32 v10, s77, v17
  v_add_u32 v11, s77, v18
  ds_read_b128 v[30:33], v9 offset:0
  ds_read_b64 v[38:39], v10 offset:2048
  ds_read_b128 v[34:37], v9 offset:1024
  v_mov_b64 v[84:85], 0
  v_mov_b64 v[86:87], 0
  v_mov_b64 v[88:89], 0
  v_mov_b64 v[90:91], 0
  v_mov_b64 v[92:93], 0
  v_mov_b64 v[94:95], 0
  v_mov_b64 v[96:97], 0
  v_mov_b64 v[98:99], 0
  s_waitcnt lgkmcnt(1)
  v_mfma_f32_32x32x16_bf16 v[100:115], v[30:33], v[20:23], v[132:147]
  v_mfma_f32_32x32x8_bf16 v[100:115], v[38:39], v[24:25], v[100:115]
  s_waitcnt lgkmcnt(0)
  v_mfma_f32_32x32x16_bf16 v[116:131], v[34:37], v[26:29], v[132:147]
  ds_read_b128 v[40:43], v11 offset:2560
  ds_read_b128 v[44:47], v11 offset:3232
  s_nop 7
  v_exp_f32 v100, v100
  v_exp_f32 v101, v101
  v_exp_f32 v102, v102
  v_cvt_pk_bf16_f32 v12, v100, v101
  v_exp_f32 v103, v103
  v_mfma_f32_32x32x8_bf16 v[116:131], v[38:39], v[54:55], v[116:131]
  v_add_u32 v9, s65, v16
  v_add_u32 v10, s65, v17
  ds_read_b128 v[30:33], v9 offset:0
  ds_read_b64 v[38:39], v10 offset:2048
  v_exp_f32 v104, v104
  v_cvt_pk_bf16_f32 v13, v102, v103
  v_exp_f32 v105, v105
  v_exp_f32 v106, v106
  v_cvt_pk_bf16_f32 v14, v104, v105
  v_exp_f32 v107, v107
  v_exp_f32 v108, v108
  v_cvt_pk_bf16_f32 v15, v106, v107
  v_exp_f32 v109, v109
  v_exp_f32 v110, v110
  v_cvt_pk_bf16_f32 v2, v108, v109
  v_exp_f32 v111, v111
  v_exp_f32 v112, v112
  v_cvt_pk_bf16_f32 v3, v110, v111
  v_exp_f32 v113, v113
  v_exp_f32 v114, v114
  v_cvt_pk_bf16_f32 v4, v112, v113
  v_exp_f32 v115, v115
  s_waitcnt lgkmcnt(0)
  v_cvt_pk_bf16_f32 v5, v114, v115
  v_mfma_f32_32x32x16_bf16 v[100:115], v[30:33], v[20:23], 0
  ds_read_b128 v[56:59], v11 offset:3904
  ds_read_b128 v[60:63], v11 offset:4576
  ds_read_b128 v[34:37], v9 offset:1024
  v_exp_f32 v116, v116
  v_exp_f32 v117, v117
  v_exp_f32 v118, v118
  v_cvt_pk_bf16_f32 v48, v116, v117
  v_exp_f32 v119, v119
  v_mfma_f32_32x32x8_bf16 v[100:115], v[38:39], v[24:25], v[100:115]
  v_exp_f32 v120, v120
  v_cvt_pk_bf16_f32 v49, v118, v119
  v_exp_f32 v121, v121
  v_exp_f32 v122, v122
  v_cvt_pk_bf16_f32 v50, v120, v121
  v_exp_f32 v123, v123
  v_mfma_f32_32x32x16_bf16 v[68:83], v[40:43], v[12:15], 0
  v_exp_f32 v124, v124
  v_cvt_pk_bf16_f32 v51, v122, v123
  v_exp_f32 v125, v125
  v_exp_f32 v126, v126
  v_cvt_pk_bf16_f32 v64, v124, v125
  v_exp_f32 v127, v127
  v_mfma_f32_32x32x16_bf16 v[68:83], v[44:47], v[2:5], v[68:83]
  v_exp_f32 v128, v128
  v_cvt_pk_bf16_f32 v65, v126, v127
  v_exp_f32 v129, v129
  v_exp_f32 v130, v130
  v_cvt_pk_bf16_f32 v66, v128, v129
  v_exp_f32 v131, v131
  s_waitcnt lgkmcnt(0)
  v_add_u32 v9, s67, v16
  v_add_u32 v10, s67, v17
  v_add_u32 v11, s67, v18
  v_cvt_pk_bf16_f32 v67, v130, v131
L_tree:
  s_cmp_ge_u32 s68, 4
  s_cbranch_scc1 L_tr4
  s_cmp_ge_u32 s68, 2
  s_cbranch_scc1 L_tr2
  s_cmp_eq_u32 s68, 0
  s_cbranch_scc1 L_ch8
  s_branch L_ch7
L_tr2:
  s_cmp_eq_u32 s68, 2
  s_cbranch_scc1 L_ch6
  s_branch L_ch5
L_tr4:
  s_cmp_eq_u32 s68, 4
  s_cbranch_scc1 L_ch4
  s_cmp_eq_u32 s68, 5
  s_cbranch_scc1 L_ch3
  s_cmp_eq_u32 s68, 6
  s_cbranch_scc1 L_ch2
L_ch1:
  v_mfma_f32_32x32x16_bf16 v[116:131], v[34:37], v[26:29], 0
  ds_read_b128 v[40:43], v11 offset:7808
  ds_read_b128 v[44:47], v11 offset:8480
  v_exp_f32 v100, v100
  v_exp_f32 v101, v101
  v_exp_f32 v102, v102
  v_cvt_pk_bf16_f32 v12, v100, v101
  v_exp_f32 v103, v103
  v_mfma_f32_32x32x8_bf16 v[116:131], v[38:39], v[54:55], v[116:131]
  ds_read_b128 v[30:33], v9 offset:10496
  ds_read_b64 v[38:39], v10 offset:12544
  v_exp_f32 v104, v104
  v_cvt_pk_bf16_f32 v13, v102, v103
  v_exp_f32 v105, v105
  v_exp_f32 v106, v106
  v_cvt_pk_bf16_f32 v14, v104, v105
  v_exp_f32 v107, v107
  v_mfma_f32_32x32x16_bf16 v[84:99], v[56:59], v[48:51], v[84:99]
  v_exp_f32 v108, v108
  v_cvt_pk_bf16_f32 v15, v106, v107
  v_exp_f32 v109, v109
  v_exp_f32 v110, v110
  v_cvt_pk_bf16_f32 v2, v108, v109
  v_exp_f32 v111, v111
  v_mfma_f32_32x32x16_bf16 v[84:99], v[60:63], v[64:67], v[84:99]
  v_exp_f32 v112, v112
  v_cvt_pk_bf16_f32 v3, v110, v111
  v_exp_f32 v113, v113
  v_exp_f32 v114, v114
  v_cvt_pk_bf16_f32 v4, v112, v113
  v_exp_f32 v115, v115
  s_waitcnt lgkmcnt(0)
  v_cvt_pk_bf16_f32 v5, v114, v115
  v_mfma_f32_32x32x16_bf16 v[100:115], v[30:33], v[20:23], 0
  ds_read_b128 v[56:59], v11 offset:9152
  ds_read_b128 v[60:63], v11 offset:9824
  ds_read_b128 v[34:37], v9 offset:11520
  v_exp_f32 v116, v116
  v_exp_f32 v117, v117
  v_exp_f32 v118, v118
  v_cvt_pk_bf16_f32 v48, v116, v117
  v_exp_f32 v119, v119
  v_mfma_f32_32x32x8_bf16 v[100:115], v[38:39], v[24:25], v[100:115]
  v_exp_f32 v120, v120
  v_cvt_pk_bf16_f32 v49, v118, v119
  v_exp_f32 v121, v121
  v_exp_f32 v122, v122
  v_cvt_pk_bf16_f32 v50, v120, v121
  v_exp_f32 v123, v123
  v_mfma_f32_32x32x16_bf16 v[68:83], v[40:43], v[12:15], v[68:83]
  v_exp_f32 v124, v124
  v_cvt_pk_bf16_f32 v51, v122, v123
  v_exp_f32 v125, v125
  v_exp_f32 v126, v126
  v_cvt_pk_bf16_f32 v64, v124, v125
  v_exp_f32 v127, v127
  v_mfma_f32_32x32x16_bf16 v[68:83], v[44:47], v[2:5], v[68:83]
  v_exp_f32 v128, v128
  v_cvt_pk_bf16_f32 v65, v126, v127
  v_exp_f32 v129, v129
  v_exp_f32 v130, v130
  v_cvt_pk_bf16_f32 v66, v128, v129
  v_exp_f32 v131, v131
  s_waitcnt lgkmcnt(0)
  v_cvt_pk_bf16_f32 v67, v130, v131
L_ch2:
  v_mfma_f32_32x32x16_bf16 v[116:131], v[34:37], v[26:29], 0
  ds_read_b128 v[40:43], v11 offset:13056
  ds_read_b128 v[44:47], v11 offset:13728
  v_exp_f32 v100, v100
  v_exp_f32 v101, v101
  v_exp_f32 v102, v102
  v_cvt_pk_bf16_f32 v12, v100, v101
  v_exp_f32 v103, v103
  v_mfma_f32_32x32x8_bf16 v[116:131], v[38:39], v[54:55], v[116:131]
  ds_read_b128 v[30:33], v9 offset:15744
  ds_read_b64 v[38:39], v10 offset:17792
  v_exp_f32 v104, v104
  v_cvt_pk_bf16_f32 v13, v102, v103
  v_exp_f32 v105, v105
  v_exp_f32 v106, v106
  v_cvt_pk_bf16_f32 v14, v104, v105
  v_exp_f32 v107, v107
  v_mfma_f32_32x32x16_bf16 v[84:99], v[56:59], v[48:51], v[84:99]
  v_exp_f32 v108, v108
  v_cvt_pk_bf16_f32 v15, v106, v107
  v_exp_f32 v109, v109
  v_exp_f32 v110, v110
  v_cvt_pk_bf16_f32 v2, v108, v109
  v_exp_f32 v111, v111
  v_mfma_f32_32x32x16_bf16 v[84:99], v[60:63], v[64:67], v[84:99]
  v_exp_f32 v112, v112
  v_cvt_pk_bf16_f32 v3, v110, v111
  v_exp_f32 v113, v113
  v_exp_f32 v114, v114
  v_cvt_pk_bf16_f32 v4, v112, v113
  v_exp_f32 v115, v115
  s_waitcnt lgkmcnt(0)
  v_cvt_pk_bf16_f32 v5, v114, v115
  v_mfma_f32_32x32x16_bf16 v[100:115], v[30:33], v[20:23], 0
  ds_read_b128 v[56:59], v11 offset:14400
  ds_read_b128 v[60:63], v11 offset:15072
  ds_read_b128 v[34:37], v9 offset:16768
  v_exp_f32 v116, v116
  v_exp_f32 v117, v117
  v_exp_f32 v118, v118
  v_cvt_pk_bf16_f32 v48, v116, v117
  v_exp_f32 v119, v119
  v_mfma_f32_32x32x8_bf16 v[100:115], v[38:39], v[24:25], v[100:115]
  v_exp_f32 v120, v120
  v_cvt_pk_bf16_f32 v49, v118, v119
  v_exp_f32 v121, v121
  v_exp_f32 v122, v122
  v_cvt_pk_bf16_f32 v50, v120, v121
  v_exp_f32 v123, v123
  v_mfma_f32_32x32x16_bf16 v[68:83], v[40:43], v[12:15], v[68:83]
  v_exp_f32 v124, v124
  v_cvt_pk_bf16_f32 v51, v122, v123
  v_exp_f32 v125, v125
  v_exp_f32 v126, v126
  v_cvt_pk_bf16_f32 v64, v124, v125
  v_exp_f32 v127, v127
  v_mfma_f32_32x32x16_bf16 v[68:83], v[44:47], v[2:5], v[68:83]
  v_exp_f32 v128, v128
  v_cvt_pk_bf16_f32 v65, v126, v127
  v_exp_f32 v129, v129
  v_exp_f32 v130, v130
  v_cvt_pk_bf16_f32 v66, v128, v129
  v_exp_f32 v131, v131
  s_waitcnt lgkmcnt(0)
  v_cvt_pk_bf16_f32 v67, v130, v131
L_ch3:
  v_mfma_f32_32x32x16_bf16 v[116:131], v[34:37], v[26:29], 0
  ds_read_b128 v[40:43], v11 offset:18304
  ds_read_b128 v[44:47], v11 offset:18976
  v_exp_f32 v100, v100
  v_exp_f32 v101, v101
  v_exp_f32 v102, v102
  v_cvt_pk_bf16_f32 v12, v100, v101
  v_exp_f32 v103, v103
  v_mfma_f32_32x32x8_bf16 v[116:131], v[38:39], v[54:55], v[116:131]
  ds_read_b128 v[30:33], v9 offset:20992
  ds_read_b64 v[38:39], v10 offset:23040
  v_exp_f32 v104, v104
  v_cvt_pk_bf16_f32 v13, v102, v103
  v_exp_f32 v105, v105
  v_exp_f32 v106, v106
  v_cvt_pk_bf16_f32 v14, v104, v105
  v_exp_f32 v107, v107
  v_mfma_f32_32x32x16_bf16 v[84:99], v[56:59], v[48:51], v[84:99]
  v_exp_f32 v108, v108
  v_cvt_pk_bf16_f32 v15, v106, v107
  v_exp_f32 v109, v109
  v_exp_f32 v110, v110
  v_cvt_pk_bf16_f32 v2, v108, v109
  v_exp_f32 v111, v111
  v_mfma_f32_32x32x16_bf16 v[84:99], v[60:63], v[64:67], v[84:99]
  v_exp_f32 v112, v112
  v_cvt_pk_bf16_f32 v3, v110, v111
  v_exp_f32 v113, v113
  v_exp_f32 v114, v114
  v_cvt_pk_bf16_f32 v4, v112, v113
  v_exp_f32 v115, v115
  s_waitcnt lgkmcnt(0)
  v_cvt_pk_bf16_f32 v5, v114, v115
  v_mfma_f32_32x32x16_bf16 v[100:115], v[30:33], v[20:23], 0
  ds_read_b128 v[56:59], v11 offset:19648
  ds_read_b128 v[60:63], v11 offset:20320
  ds_read_b128 v[34:37], v9 offset:22016
  v_exp_f32 v116, v116
  v_exp_f32 v117, v117
  v_exp_f32 v118, v118
  v_cvt_pk_bf16_f32 v48, v116, v117
  v_exp_f32 v119, v119
  v_mfma_f32_32x32x8_bf16 v[100:115], v[38:39], v[24:25], v[100:115]
  v_exp_f32 v120, v120
  v_cvt_pk_bf16_f32 v49, v118, v119
  v_exp_f32 v121, v121
  v_exp_f32 v122, v122
  v_cvt_pk_bf16_f32 v50, v120, v121
  v_exp_f32 v123, v123
  v_mfma_f32_32x32x16_bf16 v[68:83], v[40:43], v[12:15], v[68:83]
  v_exp_f32 v124, v124
  v_cvt_pk_bf16_f32 v51, v122, v123
  v_exp_f32 v125, v125
  v_exp_f32 v126, v126
  v_cvt_pk_bf16_f32 v64, v124, v125
  v_exp_f32 v127, v127
  v_mfma_f32_32x32x16_bf16 v[68:83], v[44:47], v[2:5], v[68:83]
  v_exp_f32 v128, v128
  v_cvt_pk_bf16_f32 v65, v126, v127
  v_exp_f32 v129, v129
  v_exp_f32 v130, v130
  v_cvt_pk_bf16_f32 v66, v128, v129
  v_exp_f32 v131, v131
  s_waitcnt lgkmcnt(0)
  v_cvt_pk_bf16_f32 v67, v130, v131
L_ch4:
  v_mfma_f32_32x32x16_bf16 v[116:131], v[34:37], v[26:29], 0
  ds_read_b128 v[40:43], v11 offset:23552
  ds_read_b128 v[44:47], v11 offset:24224
  v_exp_f32 v100, v100
  v_exp_f32 v101, v101
  v_exp_f32 v102, v102
  v_cvt_pk_bf16_f32 v12, v100, v101
  v_exp_f32 v103, v103
  v_mfma_f32_32x32x8_bf16 v[116:131], v[38:39], v[54:55], v[116:131]
  ds_read_b128 v[30:33], v9 offset:26240
  ds_read_b64 v[38:39], v10 offset:28288
  v_exp_f32 v104, v104
  v_cvt_pk_bf16_f32 v13, v102, v103
  v_exp_f32 v105, v105
  v_exp_f32 v106, v106
  v_cvt_pk_bf16_f32 v14, v104, v105
  v_exp_f32 v107, v107
  v_mfma_f32_32x32x16_bf16 v[84:99], v[56:59], v[48:51], v[84:99]
  v_exp_f32 v108, v108
  v_cvt_pk_bf16_f32 v15, v106, v107
  v_exp_f32 v109, v109
  v_exp_f32 v110, v110
  v_cvt_pk_bf16_f32 v2, v108, v109
  v_exp_f32 v111, v111
  v_mfma_f32_32x32x16_bf16 v[84:99], v[60:63], v[64:67], v[84:99]
  v_exp_f32 v112, v112
  v_cvt_pk_bf16_f32 v3, v110, v111
  v_exp_f32 v113, v113
  v_exp_f32 v114, v114
  v_cvt_pk_bf16_f32 v4, v112, v113
  v_exp_f32 v115, v115
  s_waitcnt lgkmcnt(0)
  v_cvt_pk_bf16_f32 v5, v114, v115
  v_mfma_f32_32x32x16_bf16 v[100:115], v[30:33], v[20:23], 0
  ds_read_b128 v[56:59], v11 offset:24896
  ds_read_b128 v[60:63], v11 offset:25568
  ds_read_b128 v[34:37], v9 offset:27264
  v_exp_f32 v116, v116
  v_exp_f32 v117, v117
  v_exp_f32 v118, v118
  v_cvt_pk_bf16_f32 v48, v116, v117
  v_exp_f32 v119, v119
  v_mfma_f32_32x32x8_bf16 v[100:115], v[38:39], v[24:25], v[100:115]
  v_exp_f32 v120, v120
  v_cvt_pk_bf16_f32 v49, v118, v119
  v_exp_f32 v121, v121
  v_exp_f32 v122, v122
  v_cvt_pk_bf16_f32 v50, v120, v121
  v_exp_f32 v123, v123
  v_mfma_f32_32x32x16_bf16 v[68:83], v[40:43], v[12:15], v[68:83]
  v_exp_f32 v124, v124
  v_cvt_pk_bf16_f32 v51, v122, v123
  v_exp_f32 v125, v125
  v_exp_f32 v126, v126
  v_cvt_pk_bf16_f32 v64, v124, v125
  v_exp_f32 v127, v127
  v_mfma_f32_32x32x16_bf16 v[68:83], v[44:47], v[2:5], v[68:83]
  v_exp_f32 v128, v128
  v_cvt_pk_bf16_f32 v65, v126, v127
  v_exp_f32 v129, v129
  v_exp_f32 v130, v130
  v_cvt_pk_bf16_f32 v66, v128, v129
  v_exp_f32 v131, v131
  s_waitcnt lgkmcnt(0)
  v_cvt_pk_bf16_f32 v67, v130, v131
L_ch5:
  v_mfma_f32_32x32x16_bf16 v[116:131], v[34:37], v[26:29], 0
  ds_read_b128 v[40:43], v11 offset:28800
  ds_read_b128 v[44:47], v11 offset:29472
  v_exp_f32 v100, v100
  v_exp_f32 v101, v101
  v_exp_f32 v102, v102
  v_cvt_pk_bf16_f32 v12, v100, v101
  v_exp_f32 v103, v103
  v_mfma_f32_32x32x8_bf16 v[116:131], v[38:39], v[54:55], v[116:131]
  ds_read_b128 v[30:33], v9 offset:31488
  ds_read_b64 v[38:39], v10 offset:33536
  v_exp_f32 v104, v104
  v_cvt_pk_bf16_f32 v13, v102, v103
  v_exp_f32 v105, v105
  v_exp_f32 v106, v106
  v_cvt_pk_bf16_f32 v14, v104, v105
  v_exp_f32 v107, v107
  v_mfma_f32_32x32x16_bf16 v[84:99], v[56:59], v[48:51], v[84:99]
  v_exp_f32 v108, v108
  v_cvt_pk_bf16_f32 v15, v106, v107
  v_exp_f32 v109, v109
  v_exp_f32 v110, v110
  v_cvt_pk_bf16_f32 v2, v108, v109
  v_exp_f32 v111, v111
  v_mfma_f32_32x32x16_bf16 v[84:99], v[60:63], v[64:67], v[84:99]
  v_exp_f32 v112, v112
  v_cvt_pk_bf16_f32 v3, v110, v111
  v_exp_f32 v113, v113
  v_exp_f32 v114, v114
  v_cvt_pk_bf16_f32 v4, v112, v113
  v_exp_f32 v115, v115
  s_waitcnt lgkmcnt(0)
  v_cvt_pk_bf16_f32 v5, v114, v115
  v_mfma_f32_32x32x16_bf16 v[100:115], v[30:33], v[20:23], 0
  ds_read_b128 v[56:59], v11 offset:30144
  ds_read_b128 v[60:63], v11 offset:30816
  ds_read_b128 v[34:37], v9 offset:32512
  v_exp_f32 v116, v116
  v_exp_f32 v117, v117
  v_exp_f32 v118, v118
  v_cvt_pk_bf16_f32 v48, v116, v117
  v_exp_f32 v119, v119
  v_mfma_f32_32x32x8_bf16 v[100:115], v[38:39], v[24:25], v[100:115]
  v_exp_f32 v120, v120
  v_cvt_pk_bf16_f32 v49, v118, v119
  v_exp_f32 v121, v121
  v_exp_f32 v122, v122
  v_cvt_pk_bf16_f32 v50, v120, v121
  v_exp_f32 v123, v123
  v_mfma_f32_32x32x16_bf16 v[68:83], v[40:43], v[12:15], v[68:83]
  v_exp_f32 v124, v124
  v_cvt_pk_bf16_f32 v51, v122, v123
  v_exp_f32 v125, v125
  v_exp_f32 v126, v126
  v_cvt_pk_bf16_f32 v64, v124, v125
  v_exp_f32 v127, v127
  v_mfma_f32_32x32x16_bf16 v[68:83], v[44:47], v[2:5], v[68:83]
  v_exp_f32 v128, v128
  v_cvt_pk_bf16_f32 v65, v126, v127
  v_exp_f32 v129, v129
  v_exp_f32 v130, v130
  v_cvt_pk_bf16_f32 v66, v128, v129
  v_exp_f32 v131, v131
  s_waitcnt lgkmcnt(0)
  v_cvt_pk_bf16_f32 v67, v130, v131
L_ch6:
  v_mfma_f32_32x32x16_bf16 v[116:131], v[34:37], v[26:29], 0
  ds_read_b128 v[40:43], v11 offset:34048
  ds_read_b128 v[44:47], v11 offset:34720
  v_exp_f32 v100, v100
  v_exp_f32 v101, v101
  v_exp_f32 v102, v102
  v_cvt_pk_bf16_f32 v12, v100, v101
  v_exp_f32 v103, v103
  v_mfma_f32_32x32x8_bf16 v[116:131], v[38:39], v[54:55], v[116:131]
  ds_read_b128 v[30:33], v9 offset:36736
  ds_read_b64 v[38:39], v10 offset:38784
  v_exp_f32 v104, v104
  v_cvt_pk_bf16_f32 v13, v102, v103
  v_exp_f32 v105, v105
  v_exp_f32 v106, v106
  v_cvt_pk_bf16_f32 v14, v104, v105
  v_exp_f32 v107, v107
  v_mfma_f32_32x32x16_bf16 v[84:99], v[56:59], v[48:51], v[84:99]
  v_exp_f32 v108, v108
  v_cvt_pk_bf16_f32 v15, v106, v107
  v_exp_f32 v109, v109
  v_exp_f32 v110, v110
  v_cvt_pk_bf16_f32 v2, v108, v109
  v_exp_f32 v111, v111
  v_mfma_f32_32x32x16_bf16 v[84:99], v[60:63], v[64:67], v[84:99]
  v_exp_f32 v112, v112
  v_cvt_pk_bf16_f32 v3, v110, v111
  v_exp_f32 v113, v113
  v_exp_f32 v114, v114
  v_cvt_pk_bf16_f32 v4, v112, v113
  v_exp_f32 v115, v115
  s_waitcnt lgkmcnt(0)
  v_cvt_pk_bf16_f32 v5, v114, v115
  v_mfma_f32_32x32x16_bf16 v[100:115], v[30:33], v[20:23], 0
  ds_read_b128 v[56:59], v11 offset:35392
  ds_read_b128 v[60:63], v11 offset:36064
  ds_read_b128 v[34:37], v9 offset:37760
  v_exp_f32 v116, v116
  v_exp_f32 v117, v117
  v_exp_f32 v118, v118
  v_cvt_pk_bf16_f32 v48, v116, v117
  v_exp_f32 v119, v119
  v_mfma_f32_32x32x8_bf16 v[100:115], v[38:39], v[24:25], v[100:115]
  v_exp_f32 v120, v120
  v_cvt_pk_bf16_f32 v49, v118, v119
  v_exp_f32 v121, v121
  v_exp_f32 v122, v122
  v_cvt_pk_bf16_f32 v50, v120, v121
  v_exp_f32 v123, v123
  v_mfma_f32_32x32x16_bf16 v[68:83], v[40:43], v[12:15], v[68:83]
  v_exp_f32 v124, v124
  v_cvt_pk_bf16_f32 v51, v122, v123
  v_exp_f32 v125, v125
  v_exp_f32 v126, v126
  v_cvt_pk_bf16_f32 v64, v124, v125
  v_exp_f32 v127, v127
  v_mfma_f32_32x32x16_bf16 v[68:83], v[44:47], v[2:5], v[68:83]
  v_exp_f32 v128, v128
  v_cvt_pk_bf16_f32 v65, v126, v127
  v_exp_f32 v129, v129
  v_exp_f32 v130, v130
  v_cvt_pk_bf16_f32 v66, v128, v129
  v_exp_f32 v131, v131
  s_waitcnt lgkmcnt(0)
  v_cvt_pk_bf16_f32 v67, v130, v131
L_ch7:
  v_mfma_f32_32x32x16_bf16 v[116:131], v[34:37], v[26:29], 0
  ds_read_b128 v[40:43], v11 offset:39296
  ds_read_b128 v[44:47], v11 offset:39968
  v_exp_f32 v100, v100
  v_exp_f32 v101, v101
  v_exp_f32 v102, v102
  v_cvt_pk_bf16_f32 v12, v100, v101
  v_exp_f32 v103, v103
  v_mfma_f32_32x32x8_bf16 v[116:131], v[38:39], v[54:55], v[116:131]
  ds_read_b128 v[30:33], v9 offset:41984
  ds_read_b64 v[38:39], v10 offset:44032
  v_exp_f32 v104, v104
  v_cvt_pk_bf16_f32 v13, v102, v103
  v_exp_f32 v105, v105
  v_exp_f32 v106, v106
  v_cvt_pk_bf16_f32 v14, v104, v105
  v_exp_f32 v107, v107
  v_mfma_f32_32x32x16_bf16 v[84:99], v[56:59], v[48:51], v[84:99]
  v_exp_f32 v108, v108
  v_cvt_pk_bf16_f32 v15, v106, v107
  v_exp_f32 v109, v109
  v_exp_f32 v110, v110
  v_cvt_pk_bf16_f32 v2, v108, v109
  v_exp_f32 v111, v111
  v_mfma_f32_32x32x16_bf16 v[84:99], v[60:63], v[64:67], v[84:99]
  v_exp_f32 v112, v112
  v_cvt_pk_bf16_f32 v3, v110, v111
  v_exp_f32 v113, v113
  v_exp_f32 v114, v114
  v_cvt_pk_bf16_f32 v4, v112, v113
  v_exp_f32 v115, v115
  s_waitcnt lgkmcnt(0)
  v_cvt_pk_bf16_f32 v5, v114, v115
  v_mfma_f32_32x32x16_bf16 v[100:115], v[30:33], v[20:23], 0
  ds_read_b128 v[56:59], v11 offset:40640
  ds_read_b128 v[60:63], v11 offset:41312
  ds_read_b128 v[34:37], v9 offset:43008
  v_exp_f32 v116, v116
  v_exp_f32 v117, v117
  v_exp_f32 v118, v118
  v_cvt_pk_bf16_f32 v48, v116, v117
  v_exp_f32 v119, v119
  v_mfma_f32_32x32x8_bf16 v[100:115], v[38:39], v[24:25], v[100:115]
  v_exp_f32 v120, v120
  v_cvt_pk_bf16_f32 v49, v118, v119
  v_exp_f32 v121, v121
  v_exp_f32 v122, v122
  v_cvt_pk_bf16_f32 v50, v120, v121
  v_exp_f32 v123, v123
  v_mfma_f32_32x32x16_bf16 v[68:83], v[40:43], v[12:15], v[68:83]
  v_exp_f32 v124, v124
  v_cvt_pk_bf16_f32 v51, v122, v123
  v_exp_f32 v125, v125
  v_exp_f32 v126, v126
  v_cvt_pk_bf16_f32 v64, v124, v125
  v_exp_f32 v127, v127
  v_mfma_f32_32x32x16_bf16 v[68:83], v[44:47], v[2:5], v[68:83]
  v_exp_f32 v128, v128
  v_cvt_pk_bf16_f32 v65, v126, v127
  v_exp_f32 v129, v129
  v_exp_f32 v130, v130
  v_cvt_pk_bf16_f32 v66, v128, v129
  v_exp_f32 v131, v131
  s_waitcnt lgkmcnt(0)
  v_cvt_pk_bf16_f32 v67, v130, v131
L_ch8:
  v_mfma_f32_32x32x16_bf16 v[84:99], v[56:59], v[48:51], v[84:99]
  s_nop 0
  v_mfma_f32_32x32x16_bf16 v[84:99], v[60:63], v[64:67], v[84:99]
  s_cmp_lg_u32 s70, 0
  s_cbranch_scc1 L_at_end
  s_mov_b32 exec_lo, 0x01000100
  s_mov_b32 exec_hi, 0x01000100
  ds_write_b128 v152, v[154:157] offset:0
  ds_write_b128 v152, v[158:161] offset:64
  s_mov_b64 exec, -1
  ds_read_b32 v19, v153
  s_mov_b32 s70, 1
  s_sub_u32 s66, s77, 70400
  s_add_u32 s65, s66, 5248
  s_mov_b32 s67, 51200
  s_sub_u32 s68, 7, s20
  s_barrier
  s_cmp_eq_u32 s23, 0
  s_cbranch_scc1 L_at_r0
  v_add_u32 v9, s66, v16
  v_add_u32 v10, s66, v17
  v_add_u32 v11, s66, v18
  ds_read_b128 v[30:33], v9 offset:0
  ds_read_b64 v[38:39], v10 offset:2048
  ds_read_b128 v[34:37], v9 offset:1024
  s_mov_b32 s74, 0xf1800000
  s_mov_b32 s75, 0xf1800000
  v_pk_add_f32 v[148:149], s[74:75], v[132:133] neg_lo:[0,1] neg_hi:[0,1]
  v_pk_add_f32 v[150:151], s[74:75], v[134:135] neg_lo:[0,1] neg_hi:[0,1]
  v_pk_add_f32 v[152:153], s[74:75], v[136:137] neg_lo:[0,1] neg_hi:[0,1]
  v_pk_add_f32 v[154:155], s[74:75], v[138:139] neg_lo:[0,1] neg_hi:[0,1]
  v_pk_add_f32 v[156:157], s[74:75], v[140:141] neg_lo:[0,1] neg_hi:[0,1]
  v_pk_add_f32 v[158:159], s[74:75], v[142:143] neg_lo:[0,1] neg_hi:[0,1]
  v_pk_add_f32 v[160:161], s[74:75], v[144:145] neg_lo:[0,1] neg_hi:[0,1]
  v_pk_add_f32 v[162:163], s[74:75], v[146:147] neg_lo:[0,1] neg_hi:[0,1]
  s_waitcnt lgkmcnt(1)
  s_nop 0
  v_mfma_f32_32x32x16_bf16 v[100:115], v[30:33], v[20:23], v[148:163]
  v_mfma_f32_32x32x8_bf16 v[100:115], v[38:39], v[24:25], v[100:115]
  v_mul_f32 v19, 0x3fb8aa3b, v19
  v_exp_f32 v19, v19
  s_nop 0
  v_add_f32 v19, 1.0, v19
  v_rcp_f32 v19, v19
  s_waitcnt lgkmcnt(0)
  v_mfma_f32_32x32x16_bf16 v[116:131], v[34:37], v[26:29], v[148:163]
  ds_read_b128 v[40:43], v11 offset:2560
  ds_read_b128 v[44:47], v11 offset:3232
  s_nop 2
  v_exp_f32 v100, v100
  v_exp_f32 v101, v101
  v_exp_f32 v102, v102
  v_cvt_pk_bf16_f32 v12, v100, v101
  v_exp_f32 v103, v103
  v_mfma_f32_32x32x8_bf16 v[116:131], v[38:39], v[54:55], v[116:131]
  v_add_u32 v9, s65, v16
  v_add_u32 v10, s65, v17
  ds_read_b128 v[30:33], v9 offset:0
  ds_read_b64 v[38:39], v10 offset:2048
  v_exp_f32 v104, v104
  v_cvt_pk_bf16_f32 v13, v102, v103
  v_exp_f32 v105, v105
  v_exp_f32 v106, v106
  v_cvt_pk_bf16_f32 v14, v104, v105
  v_exp_f32 v107, v107
  v_exp_f32 v108, v108
  v_cvt_pk_bf16_f32 v15, v106, v107
  v_exp_f32 v109, v109
  v_exp_f32 v110, v110
  v_cvt_pk_bf16_f32 v2, v108, v109
  v_exp_f32 v111, v111
  v_exp_f32 v112, v112
  v_cvt_pk_bf16_f32 v3, v110, v111
  v_exp_f32 v113, v113
  v_exp_f32 v114, v114
  v_cvt_pk_bf16_f32 v4, v112, v113
  v_exp_f32 v115, v115
  s_waitcnt lgkmcnt(0)
  v_cvt_pk_bf16_f32 v5, v114, v115
  v_mfma_f32_32x32x16_bf16 v[100:115], v[30:33], v[20:23], 0
  ds_read_b128 v[56:59], v11 offset:3904
  ds_read_b128 v[60:63], v11 offset:4576
  ds_read_b128 v[34:37], v9 offset:1024
  v_exp_f32 v116, v116
  v_exp_f32 v117, v117
  v_exp_f32 v118, v118
  v_cvt_pk_bf16_f32 v48, v116, v117
  v_exp_f32 v119, v119
  v_mfma_f32_32x32x8_bf16 v[100:115], v[38:39], v[24:25], v[100:115]
  v_exp_f32 v120, v120
  v_cvt_pk_bf16_f32 v49, v118, v119
  v_exp_f32 v121, v121
  v_exp_f32 v122, v122
  v_cvt_pk_bf16_f32 v50, v120, v121
  v_exp_f32 v123, v123
  v_mfma_f32_32x32x16_bf16 v[68:83], v[40:43], v[12:15], v[68:83]
  v_exp_f32 v124, v124
  v_cvt_pk_bf16_f32 v51, v122, v123
  v_exp_f32 v125, v125
  v_exp_f32 v126, v126
  v_cvt_pk_bf16_f32 v64, v124, v125
  v_exp_f32 v127, v127
  v_mfma_f32_32x32x16_bf16 v[68:83], v[44:47], v[2:5], v[68:83]
  v_exp_f32 v128, v128
  v_cvt_pk_bf16_f32 v65, v126, v127
  v_exp_f32 v129, v129
  v_exp_f32 v130, v130
  v_cvt_pk_bf16_f32 v66, v128, v129
  v_exp_f32 v131, v131
  s_waitcnt lgkmcnt(0)
  v_add_u32 v9, s67, v16
  v_add_u32 v10, s67, v17
  v_add_u32 v11, s67, v18
  v_cvt_pk_bf16_f32 v67, v130, v131
  s_branch L_tree
L_at_r0:
  s_waitcnt lgkmcnt(0)
  v_mul_f32 v19, 0x3fb8aa3b, v19
  v_exp_f32 v19, v19
  s_nop 0
  v_add_f32 v19, 1.0, v19
  v_rcp_f32 v19, v19
L_at_end:
  s_setprio 2
L_slow_done:
  v_rcp_f32 v80, v80
  s_nop 0
  v_mul_f32 v80, v19, v80
  v_pk_mul_f32 v[68:69], v[68:69], v[80:81] op_sel_hi:[1,0]
  v_pk_mul_f32 v[70:71], v[70:71], v[80:81] op_sel_hi:[1,0]
  v_pk_mul_f32 v[72:73], v[72:73], v[80:81] op_sel_hi:[1,0]
  v_pk_mul_f32 v[74:75], v[74:75], v[80:81] op_sel_hi:[1,0]
  v_pk_mul_f32 v[76:77], v[76:77], v[80:81] op_sel_hi:[1,0]
  v_pk_mul_f32 v[78:79], v[78:79], v[80:81] op_sel_hi:[1,0]
  v_cvt_pk_bf16_f32 v30, v68, v69
  v_cvt_pk_bf16_f32 v31, v70, v71
  v_cvt_pk_bf16_f32 v32, v72, v73
  v_cvt_pk_bf16_f32 v33, v74, v75
  buffer_store_dwordx4 v[30:33], v16, s[12:15], s72 offen offset:0 sc1
  v_cvt_pk_bf16_f32 v38, v76, v77
  v_cvt_pk_bf16_f32 v39, v78, v79
  v_rcp_f32 v96, v96
  v_min_f32 v6, v81, v97
  v_max_f32 v7, v81, v97
  v_cmp_gt_f32 vcc, 0x21800000, v6
  s_nop 0
  s_mov_b64 s[64:65], vcc
  v_cmp_lt_f32 vcc, 0x67800000, v7
  s_nop 0
  s_or_b64 vcc, vcc, s[64:65]
  s_cbranch_scc1 L_slow
  v_mul_f32 v96, v19, v96
  v_pk_mul_f32 v[84:85], v[84:85], v[96:97] op_sel_hi:[1,0]
  v_pk_mul_f32 v[86:87], v[86:87], v[96:97] op_sel_hi:[1,0]
  v_pk_mul_f32 v[88:89], v[88:89], v[96:97] op_sel_hi:[1,0]
  v_pk_mul_f32 v[90:91], v[90:91], v[96:97] op_sel_hi:[1,0]
  v_pk_mul_f32 v[92:93], v[92:93], v[96:97] op_sel_hi:[1,0]
  v_pk_mul_f32 v[94:95], v[94:95], v[96:97] op_sel_hi:[1,0]
  v_cvt_pk_bf16_f32 v34, v84, v85
  v_cvt_pk_bf16_f32 v35, v86, v87
  v_cvt_pk_bf16_f32 v36, v88, v89
  v_cvt_pk_bf16_f32 v37, v90, v91
  buffer_store_dwordx4 v[34:37], v16, s[12:15], s72 offen offset:1024 sc1
  v_cvt_pk_bf16_f32 v40, v92, v93
  v_cvt_pk_bf16_f32 v41, v94, v95
  s_mov_b32 exec_hi, 0
  buffer_store_dwordx4 v[38:41], v16, s[12:15], s72 offen offset:2048 sc1
  s_mov_b32 exec_hi, -1
  s_branch L_tail
L_compA:
  s_mov_b32 s74, 0x3fb8aa3b
  s_mov_b32 s75, 0x3fb8aa3b
  v_cvt_pk_bf16_f32 v28, v84, v85
  v_cvt_pk_bf16_f32 v30, v88, v89
  v_cvt_pk_bf16_f32 v29, v86, v87
  v_cvt_pk_bf16_f32 v31, v90, v91
  v_cvt_pk_bf16_f32 v32, v92, v93
  v_cvt_pk_bf16_f32 v34, v96, v97
  v_cvt_pk_bf16_f32 v33, v94, v95
  v_cvt_pk_bf16_f32 v35, v98, v99
  v_permlane16_swap_b32 v28, v30
  v_permlane16_swap_b32 v29, v31
  v_cvt_pk_bf16_f32 v36, v100, v101
  v_cvt_pk_bf16_f32 v38, v104, v105
  v_cvt_pk_bf16_f32 v37, v102, v103
  v_cvt_pk_bf16_f32 v39, v106, v107
  v_permlane16_swap_b32 v32, v34
  v_permlane16_swap_b32 v33, v35
  v_cvt_pk_bf16_f32 v40, v108, v109
  v_cvt_pk_bf16_f32 v41, v110, v111
  v_mfma_f32_32x32x16_bf16 v[84:99], v[132:135], v[30:33], 0
  v_permlane16_swap_b32 v36, v38
  v_permlane16_swap_b32 v37, v39
  v_cvt_pk_bf16_f32 v42, v112, v113
  v_cvt_pk_bf16_f32 v43, v114, v115
  v_mfma_f32_32x32x8_bf16 v[84:99], v[148:149], v[34:35], v[84:99]
  ds_write_b64 v164, v[40:41] offset:0
  ds_write_b64 v164, v[42:43] offset:672
  v_cvt_pk_bf16_f32 v44, v116, v117
  v_cvt_pk_bf16_f32 v45, v118, v119
  v_cvt_pk_bf16_f32 v46, v120, v121
  v_cvt_pk_bf16_f32 v47, v122, v123
  v_mfma_f32_32x32x16_bf16 v[52:67], v[140:143], v[30:33], 0
  ds_write_b64 v165, v[44:45] offset:0
  ds_write_b64 v165, v[46:47] offset:672
  v_and_b32 v2, 31, v1
  v_lshrrev_b32 v3, 5, v1
  v_bfe_u32 v4, v1, 1, 2
  v_lshlrev_b32 v5, 1, v3
  v_xor_b32 v4, v4, v5
  v_lshlrev_b32 v4, 4, v4
  v_mfma_f32_32x32x16_bf16 v[52:67], v[144:147], v[36:39], v[52:67]
  v_lshl_add_u32 v4, v2, 6, v4
  v_add_u32 v9, s77, v4
  v_xor_b32 v11, 16, v9
  v_lshlrev_b32 v3, 3, v3
  v_lshl_add_u32 v3, v2, 4, v3
  v_add_u32 v10, s77, v3
  v_mfma_f32_32x32x8_bf16 v[52:67], v[152:153], v[34:35], v[52:67]
  v_cvt_pk_bf16_f32 v48, v124, v125
  v_cvt_pk_bf16_f32 v49, v126, v127
  v_cvt_pk_bf16_f32 v50, v128, v129
  v_cvt_pk_bf16_f32 v51, v130, v131
  s_mov_b32 exec_lo, 0x03000300
  s_mov_b32 exec_hi, 0x03000300
  v_mov_b32 v48, 0x3f803f80
  v_mov_b32 v49, 0x3f803f80
  v_mov_b32 v50, 0x3f803f80
  v_mov_b32 v51, 0x3f803f80
  s_mov_b32 exec_lo, 0x03ff03ff
  s_mov_b32 exec_hi, 0x03ff03ff
  ds_write_b64 v166, v[48:49] offset:0
  ds_write_b64 v166, v[50:51] offset:672
  s_mov_b64 exec, -1
  v_mfma_f32_32x32x16_bf16 v[100:115], v[136:139], v[36:39], 0
  v_mfma_f32_32x32x8_bf16 v[100:115], v[150:151], v[34:35], v[100:115]
  v_max3_f32 v2, v84, v85, v86
  v_max3_f32 v3, v87, v88, v89
  v_max3_f32 v2, v90, v91, v2
  v_max3_f32 v3, v92, v93, v3
  v_max3_f32 v2, v94, v95, v2
  v_max3_f32 v3, v96, v97, v3
  v_max3_f32 v2, v98, v99, v2
  v_max3_f32 v3, v52, v53, v3
  v_max3_f32 v2, v54, v55, v2
  v_max_f32 v2, v2, v3
  v_mul_f32 v2, s74, v2
  v_pk_fma_f32 v[84:85], v[84:85], s[74:75], v[2:3] op_sel_hi:[1,1,0] neg_lo:[0,0,1] neg_hi:[0,0,1]
  v_pk_fma_f32 v[86:87], v[86:87], s[74:75], v[2:3] op_sel_hi:[1,1,0] neg_lo:[0,0,1] neg_hi:[0,0,1]
  v_pk_fma_f32 v[88:89], v[88:89], s[74:75], v[2:3] op_sel_hi:[1,1,0] neg_lo:[0,0,1] neg_hi:[0,0,1]
  v_pk_fma_f32 v[90:91], v[90:91], s[74:75], v[2:3] op_sel_hi:[1,1,0] neg_lo:[0,0,1] neg_hi:[0,0,1]
  v_pk_fma_f32 v[92:93], v[92:93], s[74:75], v[2:3] op_sel_hi:[1,1,0] neg_lo:[0,0,1] neg_hi:[0,0,1]
  v_pk_fma_f32 v[94:95], v[94:95], s[74:75], v[2:3] op_sel_hi:[1,1,0] neg_lo:[0,0,1] neg_hi:[0,0,1]
  v_pk_fma_f32 v[96:97], v[96:97], s[74:75], v[2:3] op_sel_hi:[1,1,0] neg_lo:[0,0,1] neg_hi:[0,0,1]
  v_pk_fma_f32 v[98:99], v[98:99], s[74:75], v[2:3] op_sel_hi:[1,1,0] neg_lo:[0,0,1] neg_hi:[0,0,1]
  v_pk_fma_f32 v[52:53], v[52:53], s[74:75], v[2:3] op_sel_hi:[1,1,0] neg_lo:[0,0,1] neg_hi:[0,0,1]
  v_pk_fma_f32 v[54:55], v[54:55], s[74:75], v[2:3] op_sel_hi:[1,1,0] neg_lo:[0,0,1] neg_hi:[0,0,1]
  v_exp_f32 v84, v84
  v_exp_f32 v85, v85
  v_exp_f32 v86, v86
  v_exp_f32 v87, v87
  v_exp_f32 v88, v88
  v_exp_f32 v89, v89
  v_pk_add_f32 v[4:5], v[84:85], v[86:87]
  v_exp_f32 v90, v90
  v_exp_f32 v91, v91
  v_pk_add_f32 v[4:5], v[4:5], v[88:89]
  v_exp_f32 v92, v92
  v_exp_f32 v93, v93
  v_pk_add_f32 v[4:5], v[4:5], v[90:91]
  v_exp_f32 v94, v94
  v_exp_f32 v95, v95
  v_pk_add_f32 v[4:5], v[4:5], v[92:93]
  v_exp_f32 v96, v96
  v_exp_f32 v97, v97
  v_pk_add_f32 v[4:5], v[4:5], v[94:95]
  v_exp_f32 v98, v98
  v_exp_f32 v99, v99
  v_pk_add_f32 v[4:5], v[4:5], v[96:97]
  v_exp_f32 v52, v52
  v_exp_f32 v53, v53
  v_pk_add_f32 v[4:5], v[4:5], v[98:99]
  v_exp_f32 v54, v54
  v_exp_f32 v55, v55
  v_pk_add_f32 v[4:5], v[4:5], v[52:53]
  v_pk_add_f32 v[4:5], v[4:5], v[54:55]
  v_add_f32 v5, v4, v5
  v_rcp_f32 v4, v5
  s_nop 0
  v_pk_mul_f32 v[84:85], v[84:85], v[4:5] op_sel_hi:[1,0]
  v_pk_mul_f32 v[86:87], v[86:87], v[4:5] op_sel_hi:[1,0]
  v_pk_mul_f32 v[88:89], v[88:89], v[4:5] op_sel_hi:[1,0]
  v_pk_mul_f32 v[90:91], v[90:91], v[4:5] op_sel_hi:[1,0]
  v_pk_mul_f32 v[92:93], v[92:93], v[4:5] op_sel_hi:[1,0]
  v_pk_mul_f32 v[94:95], v[94:95], v[4:5] op_sel_hi:[1,0]
  v_pk_mul_f32 v[96:97], v[96:97], v[4:5] op_sel_hi:[1,0]
  v_pk_mul_f32 v[98:99], v[98:99], v[4:5] op_sel_hi:[1,0]
  v_pk_mul_f32 v[52:53], v[52:53], v[4:5] op_sel_hi:[1,0]
  v_pk_mul_f32 v[54:55], v[54:55], v[4:5] op_sel_hi:[1,0]
  v_cvt_pk_bf16_f32 v154, v84, v85
  v_cvt_pk_bf16_f32 v155, v86, v87
  v_cvt_pk_bf16_f32 v156, v88, v89
  v_cvt_pk_bf16_f32 v157, v90, v91
  v_cvt_pk_bf16_f32 v158, v92, v93
  v_cvt_pk_bf16_f32 v159, v94, v95
  v_cvt_pk_bf16_f32 v160, v96, v97
  v_cvt_pk_bf16_f32 v161, v98, v99
  v_cvt_pk_bf16_f32 v162, v52, v53
  v_cvt_pk_bf16_f32 v163, v54, v55
  ds_write_b128 v9, v[154:157] offset:3072
  ds_write_b128 v11, v[158:161] offset:3072
  ds_write_b64 v10, v[162:163] offset:7168
  v_max3_f32 v2, v100, v101, v102
  v_max3_f32 v3, v103, v104, v105
  v_max3_f32 v2, v106, v107, v2
  v_max3_f32 v3, v108, v109, v3
  v_max3_f32 v2, v110, v111, v2
  v_max3_f32 v3, v112, v113, v3
  v_max3_f32 v2, v114, v115, v2
  v_max3_f32 v3, v56, v57, v3
  v_max3_f32 v2, v58, v59, v2
  v_max_f32 v2, v2, v3
  v_mul_f32 v2, s74, v2
  v_pk_fma_f32 v[100:101], v[100:101], s[74:75], v[2:3] op_sel_hi:[1,1,0] neg_lo:[0,0,1] neg_hi:[0,0,1]
  v_pk_fma_f32 v[102:103], v[102:103], s[74:75], v[2:3] op_sel_hi:[1,1,0] neg_lo:[0,0,1] neg_hi:[0,0,1]
  v_pk_fma_f32 v[104:105], v[104:105], s[74:75], v[2:3] op_sel_hi:[1,1,0] neg_lo:[0,0,1] neg_hi:[0,0,1]
  v_pk_fma_f32 v[106:107], v[106:107], s[74:75], v[2:3] op_sel_hi:[1,1,0] neg_lo:[0,0,1] neg_hi:[0,0,1]
  v_pk_fma_f32 v[108:109], v[108:109], s[74:75], v[2:3] op_sel_hi:[1,1,0] neg_lo:[0,0,1] neg_hi:[0,0,1]
  v_pk_fma_f32 v[110:111], v[110:111], s[74:75], v[2:3] op_sel_hi:[1,1,0] neg_lo:[0,0,1] neg_hi:[0,0,1]
  v_pk_fma_f32 v[112:113], v[112:113], s[74:75], v[2:3] op_sel_hi:[1,1,0] neg_lo:[0,0,1] neg_hi:[0,0,1]
  v_pk_fma_f32 v[114:115], v[114:115], s[74:75], v[2:3] op_sel_hi:[1,1,0] neg_lo:[0,0,1] neg_hi:[0,0,1]
  v_pk_fma_f32 v[56:57], v[56:57], s[74:75], v[2:3] op_sel_hi:[1,1,0] neg_lo:[0,0,1] neg_hi:[0,0,1]
  v_pk_fma_f32 v[58:59], v[58:59], s[74:75], v[2:3] op_sel_hi:[1,1,0] neg_lo:[0,0,1] neg_hi:[0,0,1]
  v_exp_f32 v100, v100
  v_exp_f32 v101, v101
  v_exp_f32 v102, v102
  v_exp_f32 v103, v103
  v_exp_f32 v104, v104
  v_exp_f32 v105, v105
  v_pk_add_f32 v[4:5], v[100:101], v[102:103]
  v_exp_f32 v106, v106
  v_exp_f32 v107, v107
  v_pk_add_f32 v[4:5], v[4:5], v[104:105]
  v_exp_f32 v108, v108
  v_exp_f32 v109, v109
  v_pk_add_f32 v[4:5], v[4:5], v[106:107]
  v_exp_f32 v110, v110
  v_exp_f32 v111, v111
  v_pk_add_f32 v[4:5], v[4:5], v[108:109]
  v_exp_f32 v112, v112
  v_exp_f32 v113, v113
  v_pk_add_f32 v[4:5], v[4:5], v[110:111]
  v_exp_f32 v114, v114
  v_exp_f32 v115, v115
  v_pk_add_f32 v[4:5], v[4:5], v[112:113]
  v_exp_f32 v56, v56
  v_exp_f32 v57, v57
  v_pk_add_f32 v[4:5], v[4:5], v[114:115]
  v_exp_f32 v58, v58
  v_exp_f32 v59, v59
  v_pk_add_f32 v[4:5], v[4:5], v[56:57]
  v_pk_add_f32 v[4:5], v[4:5], v[58:59]
  v_add_f32 v5, v4, v5
  v_rcp_f32 v4, v5
  s_nop 0
  v_pk_mul_f32 v[100:101], v[100:101], v[4:5] op_sel_hi:[1,0]
  v_pk_mul_f32 v[102:103], v[102:103], v[4:5] op_sel_hi:[1,0]
  v_pk_mul_f32 v[104:105], v[104:105], v[4:5] op_sel_hi:[1,0]
  v_pk_mul_f32 v[106:107], v[106:107], v[4:5] op_sel_hi:[1,0]
  v_pk_mul_f32 v[108:109], v[108:109], v[4:5] op_sel_hi:[1,0]
  v_pk_mul_f32 v[110:111], v[110:111], v[4:5] op_sel_hi:[1,0]
  v_pk_mul_f32 v[112:113], v[112:113], v[4:5] op_sel_hi:[1,0]
  v_pk_mul_f32 v[114:115], v[114:115], v[4:5] op_sel_hi:[1,0]
  v_pk_mul_f32 v[56:57], v[56:57], v[4:5] op_sel_hi:[1,0]
  v_pk_mul_f32 v[58:59], v[58:59], v[4:5] op_sel_hi:[1,0]
  v_cvt_pk_bf16_f32 v40, v100, v101
  v_cvt_pk_bf16_f32 v41, v102, v103
  v_cvt_pk_bf16_f32 v42, v104, v105
  v_cvt_pk_bf16_f32 v43, v106, v107
  v_cvt_pk_bf16_f32 v44, v108, v109
  v_cvt_pk_bf16_f32 v45, v110, v111
  v_cvt_pk_bf16_f32 v46, v112, v113
  v_cvt_pk_bf16_f32 v47, v114, v115
  v_cvt_pk_bf16_f32 v48, v56, v57
  v_cvt_pk_bf16_f32 v49, v58, v59
  ds_write_b128 v9, v[40:43] offset:5120
  ds_write_b128 v11, v[44:47] offset:5120
  ds_write_b64 v10, v[48:49] offset:7680
  s_waitcnt lgkmcnt(0)
  s_barrier
  v_cvt_pk_bf16_f32 v24, v76, v77
  v_cvt_pk_bf16_f32 v26, v80, v81
  v_cvt_pk_bf16_f32 v25, v78, v79
  v_cvt_pk_bf16_f32 v27, v82, v83
  v_cvt_pk_bf16_f32 v20, v68, v69
  v_cvt_pk_bf16_f32 v22, v72, v73
  v_cvt_pk_bf16_f32 v21, v70, v71
  v_cvt_pk_bf16_f32 v23, v74, v75
  v_permlane16_swap_b32 v24, v26
  v_permlane16_swap_b32 v25, v27
  v_permlane16_swap_b32 v20, v22
  v_permlane16_swap_b32 v21, v23
  s_barrier
  s_nop 0
  v_mfma_f32_32x32x16_bf16 v[84:99], v[132:135], v[20:23], 0
  v_mfma_f32_32x32x8_bf16 v[84:99], v[148:149], v[24:25], v[84:99]
  v_mfma_f32_32x32x16_bf16 v[52:67], v[140:143], v[20:23], 0
  v_mfma_f32_32x32x16_bf16 v[52:67], v[144:147], v[26:29], v[52:67]
  v_mfma_f32_32x32x8_bf16 v[52:67], v[152:153], v[24:25], v[52:67]
  v_mfma_f32_32x32x16_bf16 v[100:115], v[136:139], v[26:29], 0
  v_mfma_f32_32x32x8_bf16 v[100:115], v[150:151], v[24:25], v[100:115]
  s_lshl_b32 s64, s20, 7
  s_add_u32 s64, s64, 102400
  v_and_b32 v2, 48, v1
  v_add_u32 v2, s64, v2
  v_and_b32 v3, 31, v1
  v_lshl_add_u32 v3, v3, 2, s64
  s_mov_b32 exec_lo, 0x01000100
  s_mov_b32 exec_hi, 0x01000100
  ds_write_b128 v2, v[124:127] offset:0
  ds_write_b128 v2, v[128:131] offset:64
  s_mov_b64 exec, -1
  ds_read_b32 v19, v3
  v_and_b32 v2, 31, v1
  v_min_u32 v2, 23, v2
  v_lshrrev_b32 v3, 5, v1
  v_mad_u32_u24 v2, v3, 24, v2
  v_lshlrev_b32 v9, 4, v2
  v_lshlrev_b32 v10, 3, v2
  v_add_u32 v9, 98304, v9
  v_add_u32 v10, 98304, v10
  v_max3_f32 v2, v84, v85, v86
  v_max3_f32 v3, v87, v88, v89
  v_max3_f32 v2, v90, v91, v2
  v_max3_f32 v3, v92, v93, v3
  v_max3_f32 v2, v94, v95, v2
  v_max3_f32 v3, v96, v97, v3
  v_max3_f32 v2, v98, v99, v2
  v_max3_f32 v3, v52, v53, v3
  v_max3_f32 v2, v54, v55, v2
  v_max_f32 v2, v2, v3
  v_mul_f32 v2, s74, v2
  v_pk_fma_f32 v[84:85], v[84:85], s[74:75], v[2:3] op_sel_hi:[1,1,0] neg_lo:[0,0,1] neg_hi:[0,0,1]
  v_pk_fma_f32 v[86:87], v[86:87], s[74:75], v[2:3] op_sel_hi:[1,1,0] neg_lo:[0,0,1] neg_hi:[0,0,1]
  v_pk_fma_f32 v[88:89], v[88:89], s[74:75], v[2:3] op_sel_hi:[1,1,0] neg_lo:[0,0,1] neg_hi:[0,0,1]
  v_pk_fma_f32 v[90:91], v[90:91], s[74:75], v[2:3] op_sel_hi:[1,1,0] neg_lo:[0,0,1] neg_hi:[0,0,1]
  v_pk_fma_f32 v[92:93], v[92:93], s[74:75], v[2:3] op_sel_hi:[1,1,0] neg_lo:[0,0,1] neg_hi:[0,0,1]
  v_pk_fma_f32 v[94:95], v[94:95], s[74:75], v[2:3] op_sel_hi:[1,1,0] neg_lo:[0,0,1] neg_hi:[0,0,1]
  v_pk_fma_f32 v[96:97], v[96:97], s[74:75], v[2:3] op_sel_hi:[1,1,0] neg_lo:[0,0,1] neg_hi:[0,0,1]
  v_pk_fma_f32 v[98:99], v[98:99], s[74:75], v[2:3] op_sel_hi:[1,1,0] neg_lo:[0,0,1] neg_hi:[0,0,1]
  v_pk_fma_f32 v[52:53], v[52:53], s[74:75], v[2:3] op_sel_hi:[1,1,0] neg_lo:[0,0,1] neg_hi:[0,0,1]
  v_pk_fma_f32 v[54:55], v[54:55], s[74:75], v[2:3] op_sel_hi:[1,1,0] neg_lo:[0,0,1] neg_hi:[0,0,1]
  v_exp_f32 v84, v84
  v_exp_f32 v85, v85
  v_exp_f32 v86, v86
  v_exp_f32 v87, v87
  v_exp_f32 v88, v88
  v_exp_f32 v89, v89
  v_pk_add_f32 v[4:5], v[84:85], v[86:87]
  v_exp_f32 v90, v90
  v_exp_f32 v91, v91
  v_pk_add_f32 v[4:5], v[4:5], v[88:89]
  v_exp_f32 v92, v92
  v_exp_f32 v93, v93
  v_pk_add_f32 v[4:5], v[4:5], v[90:91]
  v_exp_f32 v94, v94
  v_exp_f32 v95, v95
  v_pk_add_f32 v[4:5], v[4:5], v[92:93]
  v_exp_f32 v96, v96
  v_exp_f32 v97, v97
  v_pk_add_f32 v[4:5], v[4:5], v[94:95]
  v_exp_f32 v98, v98
  v_exp_f32 v99, v99
  v_pk_add_f32 v[4:5], v[4:5], v[96:97]
  v_exp_f32 v52, v52
  v_exp_f32 v53, v53
  v_pk_add_f32 v[4:5], v[4:5], v[98:99]
  v_exp_f32 v54, v54
  v_exp_f32 v55, v55
  v_pk_add_f32 v[4:5], v[4:5], v[52:53]
  v_pk_add_f32 v[4:5], v[4:5], v[54:55]
  v_add_f32 v5, v4, v5
  v_rcp_f32 v4, v5
  s_nop 0
  v_pk_mul_f32 v[84:85], v[84:85], v[4:5] op_sel_hi:[1,0]
  v_pk_mul_f32 v[86:87], v[86:87], v[4:5] op_sel_hi:[1,0]
  v_pk_mul_f32 v[88:89], v[88:89], v[4:5] op_sel_hi:[1,0]
  v_pk_mul_f32 v[90:91], v[90:91], v[4:5] op_sel_hi:[1,0]
  v_pk_mul_f32 v[92:93], v[92:93], v[4:5] op_sel_hi:[1,0]
  v_pk_mul_f32 v[94:95], v[94:95], v[4:5] op_sel_hi:[1,0]
  v_pk_mul_f32 v[96:97], v[96:97], v[4:5] op_sel_hi:[1,0]
  v_pk_mul_f32 v[98:99], v[98:99], v[4:5] op_sel_hi:[1,0]
  v_pk_mul_f32 v[52:53], v[52:53], v[4:5] op_sel_hi:[1,0]
  v_pk_mul_f32 v[54:55], v[54:55], v[4:5] op_sel_hi:[1,0]
  v_cvt_pk_bf16_f32 v154, v84, v85
  v_cvt_pk_bf16_f32 v155, v86, v87
  v_cvt_pk_bf16_f32 v156, v88, v89
  v_cvt_pk_bf16_f32 v157, v90, v91
  v_cvt_pk_bf16_f32 v158, v92, v93
  v_cvt_pk_bf16_f32 v159, v94, v95
  v_cvt_pk_bf16_f32 v160, v96, v97
  v_cvt_pk_bf16_f32 v161, v98, v99
  v_cvt_pk_bf16_f32 v162, v52, v53
  v_cvt_pk_bf16_f32 v163, v54, v55
  v_max3_f32 v2, v100, v101, v102
  v_max3_f32 v3, v103, v104, v105
  v_max3_f32 v2, v106, v107, v2
  v_max3_f32 v3, v108, v109, v3
  v_max3_f32 v2, v110, v111, v2
  v_max3_f32 v3, v112, v113, v3
  v_max3_f32 v2, v114, v115, v2
  v_max3_f32 v3, v56, v57, v3
  v_max3_f32 v2, v58, v59, v2
  v_max_f32 v2, v2, v3
  v_mul_f32 v2, s74, v2
  v_pk_fma_f32 v[100:101], v[100:101], s[74:75], v[2:3] op_sel_hi:[1,1,0] neg_lo:[0,0,1] neg_hi:[0,0,1]
  v_pk_fma_f32 v[102:103], v[102:103], s[74:75], v[2:3] op_sel_hi:[1,1,0] neg_lo:[0,0,1] neg_hi:[0,0,1]
  v_pk_fma_f32 v[104:105], v[104:105], s[74:75], v[2:3] op_sel_hi:[1,1,0] neg_lo:[0,0,1] neg_hi:[0,0,1]
  v_pk_fma_f32 v[106:107], v[106:107], s[74:75], v[2:3] op_sel_hi:[1,1,0] neg_lo:[0,0,1] neg_hi:[0,0,1]
  v_pk_fma_f32 v[108:109], v[108:109], s[74:75], v[2:3] op_sel_hi:[1,1,0] neg_lo:[0,0,1] neg_hi:[0,0,1]
  v_pk_fma_f32 v[110:111], v[110:111], s[74:75], v[2:3] op_sel_hi:[1,1,0] neg_lo:[0,0,1] neg_hi:[0,0,1]
  v_pk_fma_f32 v[112:113], v[112:113], s[74:75], v[2:3] op_sel_hi:[1,1,0] neg_lo:[0,0,1] neg_hi:[0,0,1]
  v_pk_fma_f32 v[114:115], v[114:115], s[74:75], v[2:3] op_sel_hi:[1,1,0] neg_lo:[0,0,1] neg_hi:[0,0,1]
  v_pk_fma_f32 v[56:57], v[56:57], s[74:75], v[2:3] op_sel_hi:[1,1,0] neg_lo:[0,0,1] neg_hi:[0,0,1]
  v_pk_fma_f32 v[58:59], v[58:59], s[74:75], v[2:3] op_sel_hi:[1,1,0] neg_lo:[0,0,1] neg_hi:[0,0,1]
  v_exp_f32 v100, v100
  v_exp_f32 v101, v101
  v_exp_f32 v102, v102
  v_exp_f32 v103, v103
  v_exp_f32 v104, v104
  v_exp_f32 v105, v105
  v_pk_add_f32 v[4:5], v[100:101], v[102:103]
  v_exp_f32 v106, v106
  v_exp_f32 v107, v107
  v_pk_add_f32 v[4:5], v[4:5], v[104:105]
  v_exp_f32 v108, v108
  v_exp_f32 v109, v109
  v_pk_add_f32 v[4:5], v[4:5], v[106:107]
  v_exp_f32 v110, v110
  v_exp_f32 v111, v111
  v_pk_add_f32 v[4:5], v[4:5], v[108:109]
  v_exp_f32 v112, v112
  v_exp_f32 v113, v113
  v_pk_add_f32 v[4:5], v[4:5], v[110:111]
  v_exp_f32 v114, v114
  v_exp_f32 v115, v115
  v_pk_add_f32 v[4:5], v[4:5], v[112:113]
  v_exp_f32 v56, v56
  v_exp_f32 v57, v57
  v_pk_add_f32 v[4:5], v[4:5], v[114:115]
  v_exp_f32 v58, v58
  v_exp_f32 v59, v59
  v_pk_add_f32 v[4:5], v[4:5], v[56:57]
  v_pk_add_f32 v[4:5], v[4:5], v[58:59]
  v_add_f32 v5, v4, v5
  v_rcp_f32 v4, v5
  s_nop 0
  v_pk_mul_f32 v[100:101], v[100:101], v[4:5] op_sel_hi:[1,0]
  v_pk_mul_f32 v[102:103], v[102:103], v[4:5] op_sel_hi:[1,0]
  v_pk_mul_f32 v[104:105], v[104:105], v[4:5] op_sel_hi:[1,0]
  v_pk_mul_f32 v[106:107], v[106:107], v[4:5] op_sel_hi:[1,0]
  v_pk_mul_f32 v[108:109], v[108:109], v[4:5] op_sel_hi:[1,0]
  v_pk_mul_f32 v[110:111], v[110:111], v[4:5] op_sel_hi:[1,0]
  v_pk_mul_f32 v[112:113], v[112:113], v[4:5] op_sel_hi:[1,0]
  v_pk_mul_f32 v[114:115], v[114:115], v[4:5] op_sel_hi:[1,0]
  v_pk_mul_f32 v[56:57], v[56:57], v[4:5] op_sel_hi:[1,0]
  v_pk_mul_f32 v[58:59], v[58:59], v[4:5] op_sel_hi:[1,0]
  v_cvt_pk_bf16_f32 v40, v100, v101
  v_cvt_pk_bf16_f32 v41, v102, v103
  v_cvt_pk_bf16_f32 v42, v104, v105
  v_cvt_pk_bf16_f32 v43, v106, v107
  v_cvt_pk_bf16_f32 v44, v108, v109
  v_cvt_pk_bf16_f32 v45, v110, v111
  v_cvt_pk_bf16_f32 v46, v112, v113
  v_cvt_pk_bf16_f32 v47, v114, v115
  v_cvt_pk_bf16_f32 v48, v56, v57
  v_cvt_pk_bf16_f32 v49, v58, v59
  s_waitcnt lgkmcnt(0)
  v_mul_f32 v19, 0xbfb8aa3b, v19
  v_exp_f32 v19, v19
  s_nop 0
  v_add_f32 v19, 1.0, v19
  v_rcp_f32 v19, v19
  s_barrier
  s_barrier
  s_setprio 2
  ds_read_b128 v[20:23], v9 offset:0
  ds_read_b128 v[24:27], v9 offset:768
  ds_read_b64 v[28:29], v10 offset:1536
  ds_read_b128 v[30:33], v9 offset:1920
  ds_read_b128 v[34:37], v9 offset:2688
  ds_read_b64 v[38:39], v10 offset:3456
  s_waitcnt lgkmcnt(5)
  v_mfma_f32_32x32x16_bf16 v[84:99], v[20:23], v[154:157], 0
  s_waitcnt lgkmcnt(4)
  v_mfma_f32_32x32x16_bf16 v[84:99], v[24:27], v[158:161], v[84:99]
  s_waitcnt lgkmcnt(3)
  v_mfma_f32_32x32x8_bf16 v[84:99], v[28:29], v[162:163], v[84:99]
  s_waitcnt lgkmcnt(2)
  v_mfma_f32_32x32x16_bf16 v[100:115], v[30:33], v[40:43], 0
  s_waitcnt lgkmcnt(1)
  v_mfma_f32_32x32x16_bf16 v[100:115], v[34:37], v[44:47], v[100:115]
  s_waitcnt lgkmcnt(0)
  v_mfma_f32_32x32x8_bf16 v[100:115], v[38:39], v[48:49], v[100:115]
  s_nop 5
  v_add_f32 v96, 0x358637bd, v96
  v_rcp_f32 v96, v96
  s_nop 0
  v_mul_f32 v96, v19, v96
  v_pk_mul_f32 v[84:85], v[84:85], v[96:97] op_sel_hi:[1,0]
  v_pk_mul_f32 v[86:87], v[86:87], v[96:97] op_sel_hi:[1,0]
  v_pk_mul_f32 v[88:89], v[88:89], v[96:97] op_sel_hi:[1,0]
  v_pk_mul_f32 v[90:91], v[90:91], v[96:97] op_sel_hi:[1,0]
  v_pk_mul_f32 v[92:93], v[92:93], v[96:97] op_sel_hi:[1,0]
  v_pk_mul_f32 v[94:95], v[94:95], v[96:97] op_sel_hi:[1,0]
  v_cvt_pk_bf16_f32 v52, v84, v85
  v_cvt_pk_bf16_f32 v53, v86, v87
  v_cvt_pk_bf16_f32 v54, v88, v89
  v_cvt_pk_bf16_f32 v55, v90, v91
  buffer_store_dwordx4 v[52:55], v16, s[12:15], s72 offen offset:0 sc1
  v_cvt_pk_bf16_f32 v60, v92, v93
  v_cvt_pk_bf16_f32 v61, v94, v95
  v_add_f32 v112, 0x358637bd, v112
  v_rcp_f32 v112, v112
  s_nop 0
  v_mul_f32 v112, v19, v112
  v_pk_mul_f32 v[100:101], v[100:101], v[112:113] op_sel_hi:[1,0]
  v_pk_mul_f32 v[102:103], v[102:103], v[112:113] op_sel_hi:[1,0]
  v_pk_mul_f32 v[104:105], v[104:105], v[112:113] op_sel_hi:[1,0]
  v_pk_mul_f32 v[106:107], v[106:107], v[112:113] op_sel_hi:[1,0]
  v_pk_mul_f32 v[108:109], v[108:109], v[112:113] op_sel_hi:[1,0]
  v_pk_mul_f32 v[110:111], v[110:111], v[112:113] op_sel_hi:[1,0]
  v_cvt_pk_bf16_f32 v56, v100, v101
  v_cvt_pk_bf16_f32 v57, v102, v103
  v_cvt_pk_bf16_f32 v58, v104, v105
  v_cvt_pk_bf16_f32 v59, v106, v107
  buffer_store_dwordx4 v[56:59], v16, s[12:15], s72 offen offset:1024 sc1
  v_cvt_pk_bf16_f32 v62, v108, v109
  v_cvt_pk_bf16_f32 v63, v110, v111
  s_mov_b32 exec_hi, 0
  buffer_store_dwordx4 v[60:63], v16, s[12:15], s72 offen offset:2048 sc1
  s_mov_b32 exec_hi, -1
L_tail:
  s_cmp_eq_u32 s21, 0
  s_cselect_b32 s30, 0, 112384
  s_cselect_b32 s31, 102400, 0
  v_mov_b32 v2, 163816
  ds_read_b64 v[4:5], v2
  ds_read_b32 v152, v2 offset:20
  s_lshr_b32 s98, s59, 2
  s_and_b32 s99, s59, 3
  s_and_b32 s24, s99, 1
  s_lshl_b32 s24, s24, 4
  v_and_b32 v2, 15, v1
  v_add_u32 v2, s24, v2
  v_lshrrev_b32 v3, 4, v1
  v_mul_u32_u24 v7, 2560, v3
  v_lshl_add_u32 v7, v2, 4, v7
  v_lshlrev_b32 v3, 9, v3
  v_lshl_add_u32 v6, v2, 4, v3
  s_lshl_b32 s24, s96, 1
  s_lshr_b32 s25, s99, 1
  s_add_u32 s24, s24, s25
  s_mul_i32 s24, s24, 81920
  s_mul_i32 s25, s98, 10240
  s_add_u32 s72, s24, s25
  s_waitcnt lgkmcnt(0)
  v_readfirstlane_b32 s100, v4
  v_readfirstlane_b32 s101, v5
  v_readfirstlane_b32 s70, v152
  s_nop 0
  s_cmp_eq_u32 s70, 1
  s_cbranch_scc0 L_late
  s_add_u32 s24, s72, 0
  buffer_load_dwordx4 v[12:15], v6, s[12:15], s24 offen offset:0 sc1
  s_add_u32 s24, s72, 2560
  buffer_load_dwordx4 v[16:19], v6, s[12:15], s24 offen offset:0 sc1
  s_add_u32 s24, s72, 5120
  buffer_load_dwordx4 v[20:23], v6, s[12:15], s24 offen offset:0 sc1
  s_add_u32 s24, s72, 7680
  buffer_load_dwordx4 v[24:27], v6, s[12:15], s24 offen offset:0 sc1
  s_mov_b32 s16, s52
  s_mov_b32 s17, s53
  s_mov_b32 s18, 2621440
  s_mov_b32 s19, 0x20000
  s_mul_i32 s25, s98, 25600
  v_lshl_add_u32 v3, v1, 4, s25
  v_add_u32 v8, s30, v3
  v_add_u32 v9, s31, v3
  v_add_u32 v10, 51200, v3
  s_mul_i32 s24, s99, 5120
  s_add_u32 s24, s24, s31
  v_lshl_add_u32 v153, v1, 4, s24
  s_lshl_b32 s24, s96, 2
  s_add_u32 s24, s24, s99
  s_mul_i32 s24, s24, 20480
  s_mul_i32 s25, s97, 160
  s_add_u32 s68, s24, s25
  s_mul_i32 s24, s99, 4096
  s_add_u32 s24, s24, s31
  s_add_u32 s24, s24, 20480
  v_add_u32 v2, 0, v1
  v_mul_u32_u24 v3, 6554, v2
  v_lshrrev_b32 v3, 16, v3
  v_lshlrev_b32 v2, 4, v2
  v_mul_u32_u24 v155, 1120, v3
  v_add_u32 v155, v155, v2
  v_mad_u32_u24 v158, v3, 16, v2
  v_add_u32 v158, s24, v158
  v_add_u32 v2, 64, v1
  v_mul_u32_u24 v3, 6554, v2
  v_lshrrev_b32 v3, 16, v3
  v_lshlrev_b32 v2, 4, v2
  v_mul_u32_u24 v156, 1120, v3
  v_add_u32 v156, v156, v2
  v_mad_u32_u24 v159, v3, 16, v2
  v_add_u32 v159, s24, v159
  v_add_u32 v2, 128, v1
  v_mul_u32_u24 v3, 6554, v2
  v_lshrrev_b32 v3, 16, v3
  v_lshlrev_b32 v2, 4, v2
  v_mul_u32_u24 v157, 1120, v3
  v_add_u32 v157, v157, v2
  v_mad_u32_u24 v160, v3, 16, v2
  v_add_u32 v160, s24, v160
  v_and_b32 v2, 15, v1
  v_mul_u32_u24 v2, 176, v2
  v_lshrrev_b32 v3, 4, v1
  v_lshl_add_u32 v2, v3, 3, v2
  v_add_u32 v11, s24, v2
  v_mov_b32 v2, 163824
  v_mov_b32 v3, 1
  v_mov_b32 v4, s100
  v_mov_b32 v5, s101
  s_mov_b64 exec, 1
  s_waitcnt vmcnt(4)
  ds_add_rtn_u32 v3, v2, v3
  s_mov_b64 exec, 0x1
  v_lshlrev_b32 v2, 3, v1
  s_waitcnt lgkmcnt(0)
  v_cmp_eq_u32 vcc, 7, v3
  s_cbranch_vccz L_arr1
  buffer_store_dwordx2 v[4:5], v2, s[12:15], s3 offen sc1
L_arr1:
  s_mov_b64 exec, -1
  s_branch L_e
L_late:
  s_mov_b32 s16, s52
  s_mov_b32 s17, s53
  s_mov_b32 s18, 2621440
  s_mov_b32 s19, 0x20000
  s_mul_i32 s25, s98, 25600
  v_lshl_add_u32 v3, v1, 4, s25
  v_add_u32 v8, s30, v3
  v_add_u32 v9, s31, v3
  v_add_u32 v10, 51200, v3
  s_mul_i32 s24, s99, 5120
  s_add_u32 s24, s24, s31
  v_lshl_add_u32 v153, v1, 4, s24
  s_lshl_b32 s24, s96, 2
  s_add_u32 s24, s24, s99
  s_mul_i32 s24, s24, 20480
  s_mul_i32 s25, s97, 160
  s_add_u32 s68, s24, s25
  s_mul_i32 s24, s99, 4096
  s_add_u32 s24, s24, s31
  s_add_u32 s24, s24, 20480
  v_add_u32 v2, 0, v1
  v_mul_u32_u24 v3, 6554, v2
  v_lshrrev_b32 v3, 16, v3
  v_lshlrev_b32 v2, 4, v2
  v_mul_u32_u24 v155, 1120, v3
  v_add_u32 v155, v155, v2
  v_mad_u32_u24 v158, v3, 16, v2
  v_add_u32 v158, s24, v158
  v_add_u32 v2, 64, v1
  v_mul_u32_u24 v3, 6554, v2
  v_lshrrev_b32 v3, 16, v3
  v_lshlrev_b32 v2, 4, v2
  v_mul_u32_u24 v156, 1120, v3
  v_add_u32 v156, v156, v2
  v_mad_u32_u24 v159, v3, 16, v2
  v_add_u32 v159, s24, v159
  v_add_u32 v2, 128, v1
  v_mul_u32_u24 v3, 6554, v2
  v_lshrrev_b32 v3, 16, v3
  v_lshlrev_b32 v2, 4, v2
  v_mul_u32_u24 v157, 1120, v3
  v_add_u32 v157, v157, v2
  v_mad_u32_u24 v160, v3, 16, v2
  v_add_u32 v160, s24, v160
  v_and_b32 v2, 15, v1
  v_mul_u32_u24 v2, 176, v2
  v_lshrrev_b32 v3, 4, v1
  v_lshl_add_u32 v2, v3, 3, v2
  v_add_u32 v11, s24, v2
  v_mov_b32 v2, 163824
  v_mov_b32 v3, 1
  v_mov_b32 v4, s100
  v_mov_b32 v5, s101
  s_mov_b64 exec, 1
  s_waitcnt vmcnt(0)
  ds_add_rtn_u32 v3, v2, v3
  s_mov_b64 exec, 0x1
  v_lshlrev_b32 v2, 3, v1
  s_waitcnt lgkmcnt(0)
  v_cmp_eq_u32 vcc, 7, v3
  s_cbranch_vccz L_arr
  buffer_store_dwordx2 v[4:5], v2, s[12:15], s3 offen sc1
L_arr:
  s_mov_b64 exec, -1
L_e:
  s_cmp_lg_u32 s21, 1
  s_cbranch_scc1 L_noz
  s_barrier
L_noz:
  s_barrier
  s_setprio 0
  s_cmp_eq_u32 s70, 1
  s_cbranch_scc1 L_e2
  s_add_u32 s24, s72, 0
  buffer_load_dwordx4 v[12:15], v6, s[12:15], s24 offen offset:0 sc1
  s_add_u32 s24, s72, 2560
  buffer_load_dwordx4 v[16:19], v6, s[12:15], s24 offen offset:0 sc1
  s_add_u32 s24, s72, 5120
  buffer_load_dwordx4 v[20:23], v6, s[12:15], s24 offen offset:0 sc1
  s_add_u32 s24, s72, 7680
  buffer_load_dwordx4 v[24:27], v6, s[12:15], s24 offen offset:0 sc1
L_e2:
  s_add_u32 s24, s72, 0
  buffer_load_dwordx4 v[28:31], v7, s[12:15], s24 offen offset:2048 sc1
  s_add_u32 s24, s72, 20480
  buffer_load_dwordx4 v[32:35], v6, s[12:15], s24 offen offset:0 sc1
  s_add_u32 s24, s72, 23040
  buffer_load_dwordx4 v[36:39], v6, s[12:15], s24 offen offset:0 sc1
  s_add_u32 s24, s72, 25600
  buffer_load_dwordx4 v[40:43], v6, s[12:15], s24 offen offset:0 sc1
  s_add_u32 s24, s72, 28160
  buffer_load_dwordx4 v[44:47], v6, s[12:15], s24 offen offset:0 sc1
  s_add_u32 s24, s72, 20480
  buffer_load_dwordx4 v[48:51], v7, s[12:15], s24 offen offset:2048 sc1
L_go:
  ds_read_b128 v[92:95], v8 offset:0
  ds_read_b128 v[96:99], v8 offset:1024
  ds_read_b128 v[100:103], v8 offset:2048
  ds_read_b128 v[104:107], v8 offset:3072
  ds_read_b128 v[108:111], v8 offset:4096
  ds_read_b128 v[112:115], v8 offset:5120
  ds_read_b128 v[116:119], v8 offset:6144
  ds_read_b128 v[120:123], v8 offset:7168
  ds_read_b128 v[124:127], v8 offset:8192
  s_waitcnt vmcnt(9)
  s_waitcnt lgkmcnt(7)
  v_mfma_f32_16x16x32_bf16 v[132:135], v[92:95], v[12:15], 0
  ds_read_b128 v[128:131], v8 offset:9216
  v_mfma_f32_16x16x32_bf16 v[136:139], v[96:99], v[12:15], 0
  ds_read_b128 v[92:95], v8 offset:10240
  s_waitcnt lgkmcnt(7)
  v_mfma_f32_16x16x32_bf16 v[140:143], v[100:103], v[12:15], 0
  ds_read_b128 v[96:99], v8 offset:11264
  v_mfma_f32_16x16x32_bf16 v[144:147], v[104:107], v[12:15], 0
  ds_read_b128 v[100:103], v8 offset:12288
  s_waitcnt lgkmcnt(7)
  v_mfma_f32_16x16x32_bf16 v[148:151], v[108:111], v[12:15], 0
  ds_read_b128 v[104:107], v8 offset:13312
  s_waitcnt vmcnt(8)
  s_waitcnt lgkmcnt(7)
  v_mfma_f32_16x16x32_bf16 v[132:135], v[112:115], v[16:19], v[132:135]
  ds_read_b128 v[108:111], v8 offset:14336
  s_waitcnt lgkmcnt(7)
  v_mfma_f32_16x16x32_bf16 v[136:139], v[116:119], v[16:19], v[136:139]
  ds_read_b128 v[112:115], v8 offset:15360
  v_mfma_f32_16x16x32_bf16 v[140:143], v[120:123], v[16:19], v[140:143]
  ds_read_b128 v[116:119], v8 offset:16384
  s_waitcnt lgkmcnt(7)
  v_mfma_f32_16x16x32_bf16 v[144:147], v[124:127], v[16:19], v[144:147]
  ds_read_b128 v[120:123], v8 offset:17408
  v_mfma_f32_16x16x32_bf16 v[148:151], v[128:131], v[16:19], v[148:151]
  ds_read_b128 v[124:127], v8 offset:18432
  s_waitcnt vmcnt(7)
  s_waitcnt lgkmcnt(7)
  v_mfma_f32_16x16x32_bf16 v[132:135], v[92:95], v[20:23], v[132:135]
  ds_read_b128 v[128:131], v8 offset:19456
  v_mfma_f32_16x16x32_bf16 v[136:139], v[96:99], v[20:23], v[136:139]
  ds_read_b128 v[92:95], v8 offset:20480
  s_waitcnt lgkmcnt(7)
  v_mfma_f32_16x16x32_bf16 v[140:143], v[100:103], v[20:23], v[140:143]
  ds_read_b128 v[96:99], v8 offset:21504
  v_mfma_f32_16x16x32_bf16 v[144:147], v[104:107], v[20:23], v[144:147]
  ds_read_b128 v[100:103], v8 offset:22528
  s_waitcnt lgkmcnt(7)
  v_mfma_f32_16x16x32_bf16 v[148:151], v[108:111], v[20:23], v[148:151]
  ds_read_b128 v[104:107], v8 offset:23552
  s_waitcnt vmcnt(6)
  s_waitcnt lgkmcnt(7)
  v_mfma_f32_16x16x32_bf16 v[132:135], v[112:115], v[24:27], v[132:135]
  ds_read_b128 v[108:111], v8 offset:24576
  s_waitcnt lgkmcnt(7)
  v_mfma_f32_16x16x32_bf16 v[136:139], v[116:119], v[24:27], v[136:139]
  ds_read_b128 v[112:115], v9 offset:0
  v_mfma_f32_16x16x32_bf16 v[140:143], v[120:123], v[24:27], v[140:143]
  ds_read_b128 v[116:119], v9 offset:1024
  s_waitcnt lgkmcnt(7)
  v_mfma_f32_16x16x32_bf16 v[144:147], v[124:127], v[24:27], v[144:147]
  ds_read_b128 v[120:123], v9 offset:2048
  v_mfma_f32_16x16x32_bf16 v[148:151], v[128:131], v[24:27], v[148:151]
  ds_read_b128 v[124:127], v9 offset:3072
  s_waitcnt vmcnt(5)
  s_waitcnt lgkmcnt(7)
  v_mfma_f32_16x16x32_bf16 v[132:135], v[92:95], v[28:31], v[132:135]
  ds_read_b128 v[128:131], v9 offset:4096
  v_mfma_f32_16x16x32_bf16 v[136:139], v[96:99], v[28:31], v[136:139]
  ds_read_b128 v[92:95], v9 offset:5120
  s_waitcnt lgkmcnt(7)
  v_mfma_f32_16x16x32_bf16 v[140:143], v[100:103], v[28:31], v[140:143]
  ds_read_b128 v[96:99], v9 offset:6144
  v_mfma_f32_16x16x32_bf16 v[144:147], v[104:107], v[28:31], v[144:147]
  ds_read_b128 v[100:103], v9 offset:7168
  s_waitcnt lgkmcnt(7)
  v_mfma_f32_16x16x32_bf16 v[148:151], v[108:111], v[28:31], v[148:151]
  ds_read_b128 v[104:107], v9 offset:8192
  s_waitcnt vmcnt(4)
  s_waitcnt lgkmcnt(7)
  v_mfma_f32_16x16x32_bf16 v[132:135], v[112:115], v[32:35], v[132:135]
  ds_read_b128 v[108:111], v9 offset:9216
  s_waitcnt lgkmcnt(7)
  v_mfma_f32_16x16x32_bf16 v[136:139], v[116:119], v[32:35], v[136:139]
  ds_read_b128 v[112:115], v9 offset:10240
  v_mfma_f32_16x16x32_bf16 v[140:143], v[120:123], v[32:35], v[140:143]
  ds_read_b128 v[116:119], v9 offset:11264
  s_waitcnt lgkmcnt(7)
  v_mfma_f32_16x16x32_bf16 v[144:147], v[124:127], v[32:35], v[144:147]
  ds_read_b128 v[120:123], v9 offset:12288
  v_mfma_f32_16x16x32_bf16 v[148:151], v[128:131], v[32:35], v[148:151]
  ds_read_b128 v[124:127], v9 offset:13312
  s_waitcnt vmcnt(3)
  s_waitcnt lgkmcnt(7)
  v_mfma_f32_16x16x32_bf16 v[132:135], v[92:95], v[36:39], v[132:135]
  ds_read_b128 v[128:131], v9 offset:14336
  v_mfma_f32_16x16x32_bf16 v[136:139], v[96:99], v[36:39], v[136:139]
  ds_read_b128 v[92:95], v9 offset:15360
  s_waitcnt lgkmcnt(7)
  v_mfma_f32_16x16x32_bf16 v[140:143], v[100:103], v[36:39], v[140:143]
  ds_read_b128 v[96:99], v9 offset:16384
  v_mfma_f32_16x16x32_bf16 v[144:147], v[104:107], v[36:39], v[144:147]
  ds_read_b128 v[100:103], v9 offset:17408
  s_waitcnt lgkmcnt(7)
  v_mfma_f32_16x16x32_bf16 v[148:151], v[108:111], v[36:39], v[148:151]
  ds_read_b128 v[104:107], v9 offset:18432
  s_waitcnt vmcnt(2)
  s_waitcnt lgkmcnt(7)
  v_mfma_f32_16x16x32_bf16 v[132:135], v[112:115], v[40:43], v[132:135]
  ds_read_b128 v[108:111], v9 offset:19456
  s_waitcnt lgkmcnt(7)
  v_mfma_f32_16x16x32_bf16 v[136:139], v[116:119], v[40:43], v[136:139]
  ds_read_b128 v[112:115], v9 offset:20480
  v_mfma_f32_16x16x32_bf16 v[140:143], v[120:123], v[40:43], v[140:143]
  ds_read_b128 v[116:119], v9 offset:21504
  s_waitcnt lgkmcnt(7)
  v_mfma_f32_16x16x32_bf16 v[144:147], v[124:127], v[40:43], v[144:147]
  ds_read_b128 v[120:123], v9 offset:22528
  v_mfma_f32_16x16x32_bf16 v[148:151], v[128:131], v[40:43], v[148:151]
  ds_read_b128 v[124:127], v9 offset:23552
  s_barrier
  s_add_u32 s24, s72, 40960
  buffer_load_dwordx4 v[52:55], v6, s[12:15], s24 offen offset:0 sc1
  s_add_u32 s24, s72, 43520
  buffer_load_dwordx4 v[56:59], v6, s[12:15], s24 offen offset:0 sc1
  s_add_u32 s24, s72, 46080
  buffer_load_dwordx4 v[60:63], v6, s[12:15], s24 offen offset:0 sc1
  s_add_u32 s24, s72, 48640
  buffer_load_dwordx4 v[64:67], v6, s[12:15], s24 offen offset:0 sc1
  s_add_u32 s24, s72, 40960
  buffer_load_dwordx4 v[68:71], v7, s[12:15], s24 offen offset:2048 sc1
  s_waitcnt vmcnt(6)
  s_waitcnt lgkmcnt(7)
  v_mfma_f32_16x16x32_bf16 v[132:135], v[92:95], v[44:47], v[132:135]
  ds_read_b128 v[128:131], v9 offset:24576
  s_add_u32 s24, s72, 61440
  buffer_load_dwordx4 v[72:75], v6, s[12:15], s24 offen offset:0 sc1
  v_mfma_f32_16x16x32_bf16 v[136:139], v[96:99], v[44:47], v[136:139]
  ds_read_b128 v[92:95], v10 offset:0
  s_add_u32 s24, s72, 64000
  buffer_load_dwordx4 v[76:79], v6, s[12:15], s24 offen offset:0 sc1
  s_waitcnt lgkmcnt(7)
  v_mfma_f32_16x16x32_bf16 v[140:143], v[100:103], v[44:47], v[140:143]
  ds_read_b128 v[96:99], v10 offset:1024
  s_add_u32 s24, s72, 66560
  buffer_load_dwordx4 v[80:83], v6, s[12:15], s24 offen offset:0 sc1
  v_mfma_f32_16x16x32_bf16 v[144:147], v[104:107], v[44:47], v[144:147]
  ds_read_b128 v[100:103], v10 offset:2048
  s_add_u32 s24, s72, 69120
  buffer_load_dwordx4 v[84:87], v6, s[12:15], s24 offen offset:0 sc1
  s_waitcnt lgkmcnt(7)
  v_mfma_f32_16x16x32_bf16 v[148:151], v[108:111], v[44:47], v[148:151]
  ds_read_b128 v[104:107], v10 offset:3072
  s_add_u32 s24, s72, 61440
  buffer_load_dwordx4 v[88:91], v7, s[12:15], s24 offen offset:2048 sc1
  s_waitcnt vmcnt(10)
  s_waitcnt lgkmcnt(7)
  v_mfma_f32_16x16x32_bf16 v[132:135], v[112:115], v[48:51], v[132:135]
  ds_read_b128 v[108:111], v10 offset:4096
  s_waitcnt lgkmcnt(7)
  v_mfma_f32_16x16x32_bf16 v[136:139], v[116:119], v[48:51], v[136:139]
  ds_read_b128 v[112:115], v10 offset:5120
  v_mfma_f32_16x16x32_bf16 v[140:143], v[120:123], v[48:51], v[140:143]
  ds_read_b128 v[116:119], v10 offset:6144
  s_waitcnt lgkmcnt(7)
  v_mfma_f32_16x16x32_bf16 v[144:147], v[124:127], v[48:51], v[144:147]
  ds_read_b128 v[120:123], v10 offset:7168
  v_mfma_f32_16x16x32_bf16 v[148:151], v[128:131], v[48:51], v[148:151]
  ds_read_b128 v[124:127], v10 offset:8192
  s_waitcnt vmcnt(9)
  s_waitcnt lgkmcnt(7)
  v_mfma_f32_16x16x32_bf16 v[132:135], v[92:95], v[52:55], v[132:135]
  ds_read_b128 v[128:131], v10 offset:9216
  v_mfma_f32_16x16x32_bf16 v[136:139], v[96:99], v[52:55], v[136:139]
  ds_read_b128 v[92:95], v10 offset:10240
  s_waitcnt lgkmcnt(7)
  v_mfma_f32_16x16x32_bf16 v[140:143], v[100:103], v[52:55], v[140:143]
  ds_read_b128 v[96:99], v10 offset:11264
  v_mfma_f32_16x16x32_bf16 v[144:147], v[104:107], v[52:55], v[144:147]
  ds_read_b128 v[100:103], v10 offset:12288
  s_waitcnt lgkmcnt(7)
  v_mfma_f32_16x16x32_bf16 v[148:151], v[108:111], v[52:55], v[148:151]
  ds_read_b128 v[104:107], v10 offset:13312
  s_waitcnt vmcnt(8)
  s_waitcnt lgkmcnt(7)
  v_mfma_f32_16x16x32_bf16 v[132:135], v[112:115], v[56:59], v[132:135]
  ds_read_b128 v[108:111], v10 offset:14336
  s_waitcnt lgkmcnt(7)
  v_mfma_f32_16x16x32_bf16 v[136:139], v[116:119], v[56:59], v[136:139]
  ds_read_b128 v[112:115], v10 offset:15360
  v_mfma_f32_16x16x32_bf16 v[140:143], v[120:123], v[56:59], v[140:143]
  ds_read_b128 v[116:119], v10 offset:16384
  s_waitcnt lgkmcnt(7)
  v_mfma_f32_16x16x32_bf16 v[144:147], v[124:127], v[56:59], v[144:147]
  ds_read_b128 v[120:123], v10 offset:17408
  v_mfma_f32_16x16x32_bf16 v[148:151], v[128:131], v[56:59], v[148:151]
  ds_read_b128 v[124:127], v10 offset:18432
  s_waitcnt vmcnt(7)
  s_waitcnt lgkmcnt(7)
  v_mfma_f32_16x16x32_bf16 v[132:135], v[92:95], v[60:63], v[132:135]
  ds_read_b128 v[128:131], v10 offset:19456
  v_mfma_f32_16x16x32_bf16 v[136:139], v[96:99], v[60:63], v[136:139]
  ds_read_b128 v[92:95], v10 offset:20480
  s_waitcnt lgkmcnt(7)
  v_mfma_f32_16x16x32_bf16 v[140:143], v[100:103], v[60:63], v[140:143]
  ds_read_b128 v[96:99], v10 offset:21504
  v_mfma_f32_16x16x32_bf16 v[144:147], v[104:107], v[60:63], v[144:147]
  ds_read_b128 v[100:103], v10 offset:22528
  s_waitcnt lgkmcnt(7)
  v_mfma_f32_16x16x32_bf16 v[148:151], v[108:111], v[60:63], v[148:151]
  ds_read_b128 v[104:107], v10 offset:23552
  s_waitcnt vmcnt(6)
  s_waitcnt lgkmcnt(7)
  v_mfma_f32_16x16x32_bf16 v[132:135], v[112:115], v[64:67], v[132:135]
  ds_read_b128 v[108:111], v10 offset:24576
  s_waitcnt lgkmcnt(7)
  v_mfma_f32_16x16x32_bf16 v[136:139], v[116:119], v[64:67], v[136:139]
  s_barrier
  ds_read_b128 v[112:115], v8 offset:0
  v_mfma_f32_16x16x32_bf16 v[140:143], v[120:123], v[64:67], v[140:143]
  ds_read_b128 v[116:119], v8 offset:1024
  s_waitcnt lgkmcnt(7)
  v_mfma_f32_16x16x32_bf16 v[144:147], v[124:127], v[64:67], v[144:147]
  ds_read_b128 v[120:123], v8 offset:2048
  v_mfma_f32_16x16x32_bf16 v[148:151], v[128:131], v[64:67], v[148:151]
  ds_read_b128 v[124:127], v8 offset:3072
  s_waitcnt vmcnt(5)
  s_waitcnt lgkmcnt(7)
  v_mfma_f32_16x16x32_bf16 v[132:135], v[92:95], v[68:71], v[132:135]
  ds_read_b128 v[128:131], v8 offset:4096
  v_mfma_f32_16x16x32_bf16 v[136:139], v[96:99], v[68:71], v[136:139]
  ds_read_b128 v[92:95], v8 offset:5120
  s_waitcnt lgkmcnt(7)
  v_mfma_f32_16x16x32_bf16 v[140:143], v[100:103], v[68:71], v[140:143]
  ds_read_b128 v[96:99], v8 offset:6144
  v_mfma_f32_16x16x32_bf16 v[144:147], v[104:107], v[68:71], v[144:147]
  ds_read_b128 v[100:103], v8 offset:7168
  s_waitcnt lgkmcnt(7)
  v_mfma_f32_16x16x32_bf16 v[148:151], v[108:111], v[68:71], v[148:151]
  ds_read_b128 v[104:107], v8 offset:8192
  s_waitcnt vmcnt(4)
  s_waitcnt lgkmcnt(7)
  v_mfma_f32_16x16x32_bf16 v[132:135], v[112:115], v[72:75], v[132:135]
  ds_read_b128 v[108:111], v8 offset:9216
  s_waitcnt lgkmcnt(7)
  v_mfma_f32_16x16x32_bf16 v[136:139], v[116:119], v[72:75], v[136:139]
  ds_read_b128 v[112:115], v8 offset:10240
  v_mfma_f32_16x16x32_bf16 v[140:143], v[120:123], v[72:75], v[140:143]
  ds_read_b128 v[116:119], v8 offset:11264
  s_waitcnt lgkmcnt(7)
  v_mfma_f32_16x16x32_bf16 v[144:147], v[124:127], v[72:75], v[144:147]
  ds_read_b128 v[120:123], v8 offset:12288
  v_mfma_f32_16x16x32_bf16 v[148:151], v[128:131], v[72:75], v[148:151]
  ds_read_b128 v[124:127], v8 offset:13312
  s_waitcnt vmcnt(3)
  s_waitcnt lgkmcnt(7)
  v_mfma_f32_16x16x32_bf16 v[132:135], v[92:95], v[76:79], v[132:135]
  ds_read_b128 v[128:131], v8 offset:14336
  v_mfma_f32_16x16x32_bf16 v[136:139], v[96:99], v[76:79], v[136:139]
  ds_read_b128 v[92:95], v8 offset:15360
  s_waitcnt lgkmcnt(7)
  v_mfma_f32_16x16x32_bf16 v[140:143], v[100:103], v[76:79], v[140:143]
  ds_read_b128 v[96:99], v8 offset:16384
  v_mfma_f32_16x16x32_bf16 v[144:147], v[104:107], v[76:79], v[144:147]
  ds_read_b128 v[100:103], v8 offset:17408
  s_waitcnt lgkmcnt(7)
  v_mfma_f32_16x16x32_bf16 v[148:151], v[108:111], v[76:79], v[148:151]
  ds_read_b128 v[104:107], v8 offset:18432
  s_waitcnt vmcnt(2)
  s_waitcnt lgkmcnt(7)
  v_mfma_f32_16x16x32_bf16 v[132:135], v[112:115], v[80:83], v[132:135]
  ds_read_b128 v[108:111], v8 offset:19456
  s_waitcnt lgkmcnt(7)
  v_mfma_f32_16x16x32_bf16 v[136:139], v[116:119], v[80:83], v[136:139]
  ds_read_b128 v[112:115], v8 offset:20480
  v_mfma_f32_16x16x32_bf16 v[140:143], v[120:123], v[80:83], v[140:143]
  ds_read_b128 v[116:119], v8 offset:21504
  s_waitcnt lgkmcnt(7)
  v_mfma_f32_16x16x32_bf16 v[144:147], v[124:127], v[80:83], v[144:147]
  ds_read_b128 v[120:123], v8 offset:22528
  v_mfma_f32_16x16x32_bf16 v[148:151], v[128:131], v[80:83], v[148:151]
  ds_read_b128 v[124:127], v8 offset:23552
  s_waitcnt vmcnt(1)
  s_waitcnt lgkmcnt(7)
  v_mfma_f32_16x16x32_bf16 v[132:135], v[92:95], v[84:87], v[132:135]
  ds_read_b128 v[128:131], v8 offset:24576
  v_mfma_f32_16x16x32_bf16 v[136:139], v[96:99], v[84:87], v[136:139]
  s_cmp_eq_u32 s98, 0
  s_cbranch_scc0 L_fk1
  s_waitcnt lgkmcnt(6)
  v_mfma_f32_16x16x32_bf16 v[140:143], v[100:103], v[84:87], v[140:143]
  v_mfma_f32_16x16x32_bf16 v[144:147], v[104:107], v[84:87], v[144:147]
  s_waitcnt lgkmcnt(4)
  v_mfma_f32_16x16x32_bf16 v[148:151], v[108:111], v[84:87], v[148:151]
  s_waitcnt vmcnt(0)
  s_waitcnt lgkmcnt(3)
  v_mfma_f32_16x16x32_bf16 v[132:135], v[112:115], v[88:91], v[132:135]
  s_waitcnt lgkmcnt(2)
  v_mfma_f32_16x16x32_bf16 v[136:139], v[116:119], v[88:91], v[136:139]
  v_mfma_f32_16x16x32_bf16 v[140:143], v[120:123], v[88:91], v[140:143]
  s_waitcnt lgkmcnt(0)
  v_mfma_f32_16x16x32_bf16 v[144:147], v[124:127], v[88:91], v[144:147]
  v_mfma_f32_16x16x32_bf16 v[148:151], v[128:131], v[88:91], v[148:151]
  s_nop 1
  ds_write_b128 v153, v[132:135] offset:0
  s_nop 0
  ds_write_b128 v153, v[136:139] offset:1024
  ds_write_b128 v153, v[140:143] offset:2048
  s_nop 0
  ds_write_b128 v153, v[144:147] offset:3072
  ds_write_b128 v153, v[148:151] offset:4096
  s_waitcnt lgkmcnt(0)
  s_barrier
  s_branch L_end
L_fk1:
  s_barrier
  ds_read_b128 v[12:15], v153 offset:0
  ds_read_b128 v[16:19], v153 offset:1024
  ds_read_b128 v[20:23], v153 offset:2048
  ds_read_b128 v[24:27], v153 offset:3072
  ds_read_b128 v[28:31], v153 offset:4096
  s_waitcnt lgkmcnt(11)
  v_mfma_f32_16x16x32_bf16 v[140:143], v[100:103], v[84:87], v[140:143]
  v_mfma_f32_16x16x32_bf16 v[144:147], v[104:107], v[84:87], v[144:147]
  s_waitcnt lgkmcnt(9)
  v_mfma_f32_16x16x32_bf16 v[148:151], v[108:111], v[84:87], v[148:151]
  s_waitcnt vmcnt(0)
  s_waitcnt lgkmcnt(8)
  v_mfma_f32_16x16x32_bf16 v[132:135], v[112:115], v[88:91], v[132:135]
  s_waitcnt lgkmcnt(7)
  v_mfma_f32_16x16x32_bf16 v[136:139], v[116:119], v[88:91], v[136:139]
  v_mfma_f32_16x16x32_bf16 v[140:143], v[120:123], v[88:91], v[140:143]
  s_waitcnt lgkmcnt(5)
  v_mfma_f32_16x16x32_bf16 v[144:147], v[124:127], v[88:91], v[144:147]
  v_mfma_f32_16x16x32_bf16 v[148:151], v[128:131], v[88:91], v[148:151]
  s_waitcnt lgkmcnt(0)
  s_nop 0
  v_pk_add_f32 v[12:13], v[12:13], v[132:133]
  v_pk_add_f32 v[14:15], v[14:15], v[134:135]
  v_cvt_pk_bf16_f32 v32, v12, v13
  v_cvt_pk_bf16_f32 v33, v14, v15
  ds_write_b64 v11, v[32:33] offset:0
  v_pk_add_f32 v[16:17], v[16:17], v[136:137]
  v_pk_add_f32 v[18:19], v[18:19], v[138:139]
  v_cvt_pk_bf16_f32 v34, v16, v17
  v_cvt_pk_bf16_f32 v35, v18, v19
  ds_write_b64 v11, v[34:35] offset:32
  v_pk_add_f32 v[20:21], v[20:21], v[140:141]
  v_pk_add_f32 v[22:23], v[22:23], v[142:143]
  v_cvt_pk_bf16_f32 v36, v20, v21
  v_cvt_pk_bf16_f32 v37, v22, v23
  ds_write_b64 v11, v[36:37] offset:64
  v_pk_add_f32 v[24:25], v[24:25], v[144:145]
  v_pk_add_f32 v[26:27], v[26:27], v[146:147]
  v_cvt_pk_bf16_f32 v38, v24, v25
  v_cvt_pk_bf16_f32 v39, v26, v27
  ds_write_b64 v11, v[38:39] offset:96
  v_pk_add_f32 v[28:29], v[28:29], v[148:149]
  v_pk_add_f32 v[30:31], v[30:31], v[150:151]
  v_cvt_pk_bf16_f32 v40, v28, v29
  v_cvt_pk_bf16_f32 v41, v30, v31
  ds_write_b64 v11, v[40:41] offset:128
  ds_read_b128 v[44:47], v158
  ds_read_b128 v[48:51], v159
  ds_read_b128 v[52:55], v160
  s_waitcnt lgkmcnt(2)
  buffer_store_dwordx4 v[44:47], v155, s[16:19], s68 offen
  s_waitcnt lgkmcnt(1)
  buffer_store_dwordx4 v[48:51], v156, s[16:19], s68 offen
  s_waitcnt lgkmcnt(0)
  s_mov_b32 exec_hi, 0
  buffer_store_dwordx4 v[52:55], v157, s[16:19], s68 offen
  s_mov_b32 exec_hi, -1
L_end:
L_exit:
  s_endpgm
L_slow:
  s_mov_b32 s74, 0xf1800000
  s_mov_b32 s75, 0xf1800000
  v_pk_add_f32 v[148:149], s[74:75], v[132:133] neg_lo:[0,1] neg_hi:[0,1]
  v_pk_add_f32 v[150:151], s[74:75], v[134:135] neg_lo:[0,1] neg_hi:[0,1]
  v_pk_add_f32 v[152:153], s[74:75], v[136:137] neg_lo:[0,1] neg_hi:[0,1]
  v_pk_add_f32 v[154:155], s[74:75], v[138:139] neg_lo:[0,1] neg_hi:[0,1]
  v_pk_add_f32 v[156:157], s[74:75], v[140:141] neg_lo:[0,1] neg_hi:[0,1]
  v_pk_add_f32 v[158:159], s[74:75], v[142:143] neg_lo:[0,1] neg_hi:[0,1]
  v_pk_add_f32 v[160:161], s[74:75], v[144:145] neg_lo:[0,1] neg_hi:[0,1]
  v_pk_add_f32 v[162:163], s[74:75], v[146:147] neg_lo:[0,1] neg_hi:[0,1]
  s_mov_b32 s70, 0
  v_mov_b32 v6, 0xff800000
  v_mov_b32 v7, 0xff800000
  v_mov_b32 v8, 0
  v_mov_b32 v53, 0
L_sl_pass:
  s_lshl_b32 s65, s23, 3
  s_add_u32 s65, s65, s20
  s_min_u32 s68, s65, 8
  s_lshl_b32 s64, s22, 6
  s_add_u32 s65, s65, s64
  s_sub_u32 s65, s65, s68
  s_mul_i32 s65, s65, 5248
  s_add_u32 s65, s65, 6291456
L_sl_blk:
  s_add_u32 s64, s65, 2560
  buffer_load_dwordx4 v[30:33], v16, s[12:15], s65 offen offset:0 sc1
  buffer_load_dwordx4 v[34:37], v16, s[12:15], s65 offen offset:1024 sc1
  buffer_load_dwordx2 v[38:39], v17, s[12:15], s65 offen offset:2048 sc1
  buffer_load_dwordx4 v[40:43], v18, s[12:15], s64 offen offset:0 sc1
  buffer_load_dwordx4 v[44:47], v18, s[12:15], s64 offen offset:672 sc1
  buffer_load_dwordx4 v[56:59], v18, s[12:15], s64 offen offset:1344 sc1
  buffer_load_dwordx4 v[60:63], v18, s[12:15], s64 offen offset:2016 sc1
  s_cmp_eq_u32 s68, 8
  s_cselect_b32 s66, 1.0, 0
  s_cmp_eq_u32 s68, 0
  s_cselect_b32 s67, 1.0, 0
  v_fma_f32 v100, v148, s66, v8
  v_fma_f32 v100, v132, s67, v100
  v_fma_f32 v101, v149, s66, v8
  v_fma_f32 v101, v133, s67, v101
  v_fma_f32 v102, v150, s66, v8
  v_fma_f32 v102, v134, s67, v102
  v_fma_f32 v103, v151, s66, v8
  v_fma_f32 v103, v135, s67, v103
  v_fma_f32 v104, v152, s66, v8
  v_fma_f32 v104, v136, s67, v104
  v_fma_f32 v105, v153, s66, v8
  v_fma_f32 v105, v137, s67, v105
  v_fma_f32 v106, v154, s66, v8
  v_fma_f32 v106, v138, s67, v106
  v_fma_f32 v107, v155, s66, v8
  v_fma_f32 v107, v139, s67, v107
  v_fma_f32 v108, v156, s66, v8
  v_fma_f32 v108, v140, s67, v108
  v_fma_f32 v109, v157, s66, v8
  v_fma_f32 v109, v141, s67, v109
  v_fma_f32 v110, v158, s66, v8
  v_fma_f32 v110, v142, s67, v110
  v_fma_f32 v111, v159, s66, v8
  v_fma_f32 v111, v143, s67, v111
  v_fma_f32 v112, v160, s66, v8
  v_fma_f32 v112, v144, s67, v112
  v_fma_f32 v113, v161, s66, v8
  v_fma_f32 v113, v145, s67, v113
  v_fma_f32 v114, v162, s66, v8
  v_fma_f32 v114, v146, s67, v114
  v_fma_f32 v115, v163, s66, v8
  v_fma_f32 v115, v147, s67, v115
  v_fma_f32 v116, v148, s66, v53
  v_fma_f32 v116, v132, s67, v116
  v_fma_f32 v117, v149, s66, v53
  v_fma_f32 v117, v133, s67, v117
  v_fma_f32 v118, v150, s66, v53
  v_fma_f32 v118, v134, s67, v118
  v_fma_f32 v119, v151, s66, v53
  v_fma_f32 v119, v135, s67, v119
  v_fma_f32 v120, v152, s66, v53
  v_fma_f32 v120, v136, s67, v120
  v_fma_f32 v121, v153, s66, v53
  v_fma_f32 v121, v137, s67, v121
  v_fma_f32 v122, v154, s66, v53
  v_fma_f32 v122, v138, s67, v122
  v_fma_f32 v123, v155, s66, v53
  v_fma_f32 v123, v139, s67, v123
  v_fma_f32 v124, v156, s66, v53
  v_fma_f32 v124, v140, s67, v124
  v_fma_f32 v125, v157, s66, v53
  v_fma_f32 v125, v141, s67, v125
  v_fma_f32 v126, v158, s66, v53
  v_fma_f32 v126, v142, s67, v126
  v_fma_f32 v127, v159, s66, v53
  v_fma_f32 v127, v143, s67, v127
  v_fma_f32 v128, v160, s66, v53
  v_fma_f32 v128, v144, s67, v128
  v_fma_f32 v129, v161, s66, v53
  v_fma_f32 v129, v145, s67, v129
  v_fma_f32 v130, v162, s66, v53
  v_fma_f32 v130, v146, s67, v130
  v_fma_f32 v131, v163, s66, v53
  v_fma_f32 v131, v147, s67, v131
  s_waitcnt vmcnt(0)
  v_mfma_f32_32x32x16_bf16 v[100:115], v[30:33], v[20:23], v[100:115]
  v_mfma_f32_32x32x8_bf16 v[100:115], v[38:39], v[24:25], v[100:115]
  v_mfma_f32_32x32x16_bf16 v[116:131], v[34:37], v[26:29], v[116:131]
  v_mfma_f32_32x32x8_bf16 v[116:131], v[38:39], v[54:55], v[116:131]
  s_cmp_eq_u32 s70, 0
  s_cbranch_scc0 L_sl_exp
  s_nop 7
  v_max3_f32 v6, v100, v101, v6
  v_max3_f32 v6, v102, v103, v6
  v_max3_f32 v6, v104, v105, v6
  v_max3_f32 v6, v106, v107, v6
  v_max3_f32 v6, v108, v109, v6
  v_max3_f32 v6, v110, v111, v6
  v_max3_f32 v6, v112, v113, v6
  v_max3_f32 v6, v114, v115, v6
  v_max3_f32 v7, v116, v117, v7
  v_max3_f32 v7, v118, v119, v7
  v_max3_f32 v7, v120, v121, v7
  v_max3_f32 v7, v122, v123, v7
  v_max3_f32 v7, v124, v125, v7
  v_max3_f32 v7, v126, v127, v7
  v_max3_f32 v7, v128, v129, v7
  v_max3_f32 v7, v130, v131, v7
  s_branch L_sl_next
L_sl_exp:
  s_nop 7
  v_exp_f32 v100, v100
  v_exp_f32 v101, v101
  v_exp_f32 v102, v102
  v_cvt_pk_bf16_f32 v12, v100, v101
  v_exp_f32 v103, v103
  v_exp_f32 v104, v104
  v_cvt_pk_bf16_f32 v13, v102, v103
  v_exp_f32 v105, v105
  v_exp_f32 v106, v106
  v_cvt_pk_bf16_f32 v14, v104, v105
  v_exp_f32 v107, v107
  v_exp_f32 v108, v108
  v_cvt_pk_bf16_f32 v15, v106, v107
  v_exp_f32 v109, v109
  v_exp_f32 v110, v110
  v_cvt_pk_bf16_f32 v2, v108, v109
  v_exp_f32 v111, v111
  v_exp_f32 v112, v112
  v_cvt_pk_bf16_f32 v3, v110, v111
  v_exp_f32 v113, v113
  v_exp_f32 v114, v114
  v_cvt_pk_bf16_f32 v4, v112, v113
  v_exp_f32 v115, v115
  s_nop 0
  v_cvt_pk_bf16_f32 v5, v114, v115
  v_mfma_f32_32x32x16_bf16 v[68:83], v[40:43], v[12:15], v[68:83]
  s_nop 0
  v_mfma_f32_32x32x16_bf16 v[68:83], v[44:47], v[2:5], v[68:83]
  v_exp_f32 v116, v116
  v_exp_f32 v117, v117
  v_exp_f32 v118, v118
  v_cvt_pk_bf16_f32 v48, v116, v117
  v_exp_f32 v119, v119
  v_exp_f32 v120, v120
  v_cvt_pk_bf16_f32 v49, v118, v119
  v_exp_f32 v121, v121
  v_exp_f32 v122, v122
  v_cvt_pk_bf16_f32 v50, v120, v121
  v_exp_f32 v123, v123
  v_exp_f32 v124, v124
  v_cvt_pk_bf16_f32 v51, v122, v123
  v_exp_f32 v125, v125
  v_exp_f32 v126, v126
  v_cvt_pk_bf16_f32 v64, v124, v125
  v_exp_f32 v127, v127
  v_exp_f32 v128, v128
  v_cvt_pk_bf16_f32 v65, v126, v127
  v_exp_f32 v129, v129
  v_exp_f32 v130, v130
  v_cvt_pk_bf16_f32 v66, v128, v129
  v_exp_f32 v131, v131
  s_nop 0
  v_cvt_pk_bf16_f32 v67, v130, v131
  v_mfma_f32_32x32x16_bf16 v[84:99], v[56:59], v[48:51], v[84:99]
  s_nop 0
  v_mfma_f32_32x32x16_bf16 v[84:99], v[60:63], v[64:67], v[84:99]
L_sl_next:
  s_add_u32 s65, s65, 5248
  s_sub_u32 s68, s68, 1
  s_cbranch_scc0 L_sl_blk
  s_cmp_eq_u32 s70, 0
  s_cbranch_scc0 L_slow_done
  s_mov_b32 s70, 1
  v_mov_b32 v8, v6
  v_mov_b64 v[68:69], 0
  v_mov_b64 v[70:71], 0
  v_mov_b64 v[72:73], 0
  v_mov_b64 v[74:75], 0
  v_mov_b64 v[76:77], 0
  v_mov_b64 v[78:79], 0
  v_mov_b64 v[80:81], 0
  v_mov_b64 v[82:83], 0
  v_permlane32_swap_b32 v6, v8
  v_max_f32 v6, v6, v8
  v_sub_f32 v8, 0, v6
  v_mov_b32 v53, v7
  v_mov_b64 v[84:85], 0
  v_mov_b64 v[86:87], 0
  v_mov_b64 v[88:89], 0
  v_mov_b64 v[90:91], 0
  v_mov_b64 v[92:93], 0
  v_mov_b64 v[94:95], 0
  v_mov_b64 v[96:97], 0
  v_mov_b64 v[98:99], 0
  v_permlane32_swap_b32 v7, v53
  v_max_f32 v7, v7, v53
  v_sub_f32 v53, 0, v7
  s_branch L_sl_pass
.section .rodata,"a"
.p2align 6
.amdhsa_kernel gated_mix__linear_kernel_hedgehog__sliding_block__prompt_kernel
  .amdhsa_next_free_vgpr 168
  .amdhsa_next_free_sgpr 102
  .amdhsa_accum_offset 168
  .amdhsa_group_segment_fixed_size 0
  .amdhsa_kernarg_size 88
  .amdhsa_user_sgpr_count 2
  .amdhsa_user_sgpr_kernarg_segment_ptr 1
  .amdhsa_system_sgpr_workgroup_id_x 1
.end_amdhsa_kernel
```
